```python
import torch

def _softmax(x, axis=-1):
    return torch.softmax(x, dim=axis)
def _gelu(x):
    return torch.nn.functional.gelu(x, approximate="tanh")
def _silu(x):
    return torch.nn.functional.silu(x)
def _sigmoid(x):
    return torch.sigmoid(x)
def _layernorm(x, axis=-1, eps=1e-5):
    m = x.mean(dim=axis, keepdim=True)
    v = x.var(dim=axis, keepdim=True, unbiased=False)
    return (x - m) / torch.sqrt(v + eps)
def _scatter_add(tgt, idx, src, axis=0):
    return tgt.clone().index_add_(axis, idx, src)
def _segment_sum(src, seg, n):
    out = torch.zeros((n,) + src.shape[1:], dtype=src.dtype)
    return out.index_add_(0, seg, src)
def _pad(x, pw):
    flat = tuple(v for pair in reversed(pw) for v in pair)
    return torch.nn.functional.pad(x, flat)

kernel_name = 'gated_mix__linear_attn_block__mixer_token_mlp__prompt'

def setup_inputs():

    _w = (lambda a: (lambda t: t.to(torch.bfloat16) if t.is_floating_point() else t)(torch.as_tensor(a)))
    def _A_setup():
        B, S, D = 1, 2048, 640
        return {
            "x": _w((lambda *s: torch.randn(*s, dtype=torch.bfloat16) * 0.05)(B, S, D)),
            "wqkv": _w((lambda *s: torch.randn(*s, dtype=torch.bfloat16) * 0.4)(D, 3 * D)),
            "wo": _w((lambda *s: torch.randn(*s, dtype=torch.bfloat16) * 0.05)(D, D)),
        }
    _A_in = _A_setup()

    def _B_setup():
        B, S, D, F = 1, 2048, 640, 1536
        return {
            "x": _w((lambda *s: torch.randn(*s, dtype=torch.bfloat16) * 0.05)(B, S, D)),
            "w1": _w((lambda *s: torch.randn(*s, dtype=torch.bfloat16) * 0.4)(S, F) * (S ** -0.5)),
            "b1": _w((lambda *s: torch.randn(*s, dtype=torch.bfloat16) * 3.2)(F) * 0.02),
            "w2": _w((lambda *s: torch.randn(*s, dtype=torch.bfloat16) * 0.05)(F, S) * (F ** -0.5)),
            "b2": _w((lambda *s: torch.randn(*s, dtype=torch.bfloat16) * 0.1)(S) * 0.02),
        }
    _B_in = _B_setup()

    return {
        "A_x": _A_in["x"],
        "A_wqkv": _A_in["wqkv"],
        "A_wo": _A_in["wo"],
        "B_x": _B_in["x"],
        "B_w1": _B_in["w1"],
        "B_b1": _B_in["b1"],
        "B_w2": _B_in["w2"],
        "B_b2": _B_in["b2"],
        "gate_w": _w((lambda *s: torch.randn(*s, dtype=torch.bfloat16) * 0.05)(640) * 16.0),
    }

def reference(A_x, A_wqkv, A_wo, B_x, B_w1, B_b1, B_w2, B_b2, gate_w):
    def _A_ref(x, wqkv, wo):
        B, S, D = x.shape
        H = 32; Dh = D // H
        qkv = (lambda x, *d: x.permute(*d))((x @ wqkv).reshape(B, S, 3, H, Dh), 2, 0, 3, 1, 4)
        q, k, v = qkv[0], qkv[1], qkv[2]
        phi = lambda t: torch.where(t > 0, t + 1, torch.exp(t)) + 1e-6
        pq, pk = phi(q), phi(k)
        kv = torch.einsum("bhsd,bhse->bhde", pk, v)
        z = torch.einsum("bhsd->bhd", pk)
        num = torch.einsum("bhqd,bhde->bhqe", pq, kv)
        den = torch.einsum("bhqd,bhd->bhq", pq, z)[..., None] + 1e-6
        o = num / den
        return (lambda x, *d: x.permute(*d))(o, 0, 2, 1, 3).reshape(B, S, D) @ wo

    def _B_ref(x, w1, b1, w2, b2):
        B, S, D = x.shape
        h = _layernorm(x, axis=-1)
        u = torch.einsum("bsd,sf->bdf", h, w1) + b1
        u = _gelu(u)
        y = torch.einsum("bdf,fs->bds", u, w2) + b2
        return (lambda x, *d: x.permute(*d))(y, 0, 2, 1)

    x = A_x
    g = _sigmoid((x * gate_w).sum(-1, keepdims=True))
    a = _A_ref(x, A_wqkv, A_wo)
    b = _B_ref(x, B_w1, B_b1, B_w2, B_b2)
    return g * a + (1 - g) * b
```

```asm
; @launch grid=(256,1,1) block=(512,1,1) lds=163840
.amdgcn_target "amdgcn-amd-amdhsa--gfx950"
.text
.globl gated_mix__linear_attn_block__mixer_token_mlp__prompt_kernel
.p2align 8
.type gated_mix__linear_attn_block__mixer_token_mlp__prompt_kernel,@function
gated_mix__linear_attn_block__mixer_token_mlp__prompt_kernel:
    s_cmp_ge_u32 s2, 256
    s_cbranch_scc1 L_exit
    s_load_dwordx16 s[4:19], s[0:1], 0
    s_load_dwordx8 s[20:27], s[0:1], 64
    s_getpc_b64 s[60:61]
L_pcref:
    s_lshr_b32 s3, s2, 3
    s_mul_i32 s3, s3, 1280
    v_lshlrev_b32 v4, 7, v0
    v_add_u32 v4, s3, v4
    v_min_u32 v4, L_exit-L_pcref, v4
    v_cmp_gt_u32 vcc, 10, v0
    s_and_saveexec_b64 s[62:63], vcc
    s_cbranch_execz L_nocpf
    global_load_dword v253, v4, s[60:61]
L_nocpf:
    s_mov_b64 exec, -1
    v_and_b32 v1, 63, v0
    v_lshrrev_b32 v2, 6, v0
    s_and_b32 s30, s2, 7
    v_readfirstlane_b32 s29, v2
    s_lshr_b32 s31, s2, 3
    s_waitcnt lgkmcnt(0)
    s_load_dword s28, s[26:27], 0
    s_mov_b32 s32, s26
    s_and_b32 s33, s27, 0xffff
    s_mov_b32 s34, 0xa00000
    s_mov_b32 s35, 0x20000
    s_mov_b32 s36, s4
    s_and_b32 s37, s5, 0xffff
    s_mov_b32 s38, 0x280000
    s_mov_b32 s39, 0x20000
    s_mov_b32 s48, s16
    s_and_b32 s49, s17, 0xffff
    s_mov_b32 s50, 0x600000
    s_mov_b32 s51, 0x20000
    s_lshr_b32 s60, s30, 1
    s_lshl_b32 s60, s60, 3
    s_lshr_b32 s76, s31, 2
    s_add_u32 s76, s76, s60
    s_and_b32 s60, s30, 1
    s_lshl_b32 s60, s60, 2
    s_and_b32 s77, s31, 3
    s_add_u32 s77, s77, s60
    s_cmp_lt_u32 s30, 4
    s_cbranch_scc1 L_roleB
L_roleA:
    s_mov_b32 s95, 1
    s_sub_u32 s70, s76, 16
    s_mov_b32 s71, s77
    s_cmp_ge_u32 s29, 4
    s_cbranch_scc1 L_A_loader
    s_mov_b32 s40, s6
    s_and_b32 s41, s7, 0xffff
    s_mov_b32 s42, 0x258000
    s_mov_b32 s43, 0x20000
    s_lshl_b32 s60, s31, 2
    s_add_u32 s60, s60, s29
    v_lshrrev_b32 v16, 2, v1
    v_and_b32 v17, 3, v1
    v_mul_u32_u24 v16, 1280, v16
    v_lshl_add_u32 v16, v17, 7, v16
    s_lshr_b32 s62, s70, 3
    s_lshl_b32 s62, s62, 7
    s_add_u32 s62, s62, s60
    s_mul_i32 s72, s62, 10240
    v_lshrrev_b32 v19, 4, v1
    v_and_b32 v17, 15, v1
    v_min_u32 v17, 14, v17
    v_mul_u32_u24 v18, 13, v17
    v_lshrrev_b32 v18, 6, v18
    v_mul_u32_u24 v18, 640, v18
    v_lshl_add_u32 v18, v17, 7, v18
    v_mul_u32_u24 v19, 3840, v19
    v_add_u32 v112, v18, v19
    s_lshr_b32 s62, s71, 2
    s_mul_i32 s62, s62, 640
    s_mul_i32 s73, s60, 7680
    s_add_u32 s73, s73, s62
    s_mov_b32 exec_hi, 0
    buffer_load_dword v253, v112, s[40:43], s73 offen
    buffer_load_dword v253, v16, s[36:39], s72 offen
    s_mov_b32 exec_hi, -1
    s_mul_i32 s73, s60, 11520
    s_add_u32 s73, s73, s62
    s_add_u32 s73, s73, 983040
    v_lshrrev_b32 v16, 3, v1
    v_and_b32 v17, 7, v1
    v_min_u32 v17, 5, v17
    v_mul_u32_u24 v16, 1280, v16
    v_lshl_add_u32 v113, v17, 7, v16
    s_add_u32 s72, s72, 512
    v_mul_u32_u24 v16, 625, v0
    v_lshrrev_b32 v16, 16, v16
    v_mul_u32_u24 v17, 105, v16
    v_sub_u32 v17, v0, v17
    v_mul_u32_u24 v19, 205, v17
    v_lshrrev_b32 v19, 12, v19
    v_mul_u32_u24 v18, 20, v19
    v_cmp_lt_u32 vcc, 99, v17
    v_sub_u32 v18, v17, v18
    s_nop 0
    v_cndmask_b32 v19, v19, v18, vcc
    v_mad_u32_u24 v19, v16, 5, v19
    v_mad_u32_u24 v20, v16, 20, v18
    v_lshrrev_b32 v21, 2, v19
    v_and_b32 v22, 3, v19
    v_lshrrev_b32 v23, 4, v20
    v_and_b32 v20, 15, v20
    v_lshl_add_u32 v20, v22, 4, v20
    v_lshl_add_u32 v2, v21, 1, v23
    v_lshlrev_b32 v2, 6, v2
    v_add_u32 v2, v2, v20
    v_lshlrev_b32 v2, 4, v2
    v_lshlrev_b32 v3, 4, v19
    v_add_u32 v3, 13312, v3
    v_cmp_lt_u32 vcc, 99, v17
    v_lshrrev_b32 v24, 1, v21
    v_and_b32 v21, 1, v21
    v_cndmask_b32 v2, v2, v3, vcc
    v_lshl_add_u32 v3, v23, 1, v24
    v_add_u32 v24, 11, v24
    v_lshl_add_u32 v22, v22, 4, v16
    v_cndmask_b32 v3, v3, v24, vcc
    v_cndmask_b32 v20, v20, v22, vcc
    v_lshl_add_u32 v3, v3, 6, v20
    v_lshlrev_b32 v3, 4, v3
    v_lshl_add_u32 v3, v21, 3, v3
    v_add_u32 v3, 147456, v3
    v_mov_b32 v25, 2
    v_cndmask_b32 v25, 1, v25, vcc
    v_mov_b32 v16, 420
    v_cmp_gt_u32 vcc, v16, v0
    v_lshlrev_b32 v14, 4, v0
    s_nop 0
    v_cndmask_b32 v15, 0, v25, vcc
    v_cndmask_b32 v2, 0, v2, vcc
    v_add_u32 v2, 106496, v2
    v_and_b32 v16, 15, v1
    v_lshrrev_b32 v17, 4, v1
    s_lshl_b32 s60, s29, 5
    v_add_u32 v18, s60, v16
    v_lshrrev_b32 v19, 1, v16
    v_xor_b32 v19, v17, v19
    v_lshlrev_b32 v19, 4, v19
    v_lshl_add_u32 v4, v18, 7, v19
    v_xor_b32 v5, 64, v4
    v_lshrrev_b32 v18, 2, v16
    v_lshl_add_u32 v19, v17, 3, v18
    v_and_b32 v20, 1, v17
    v_lshl_or_b32 v20, v20, 2, v18
    v_lshlrev_b32 v19, 9, v19
    v_lshl_add_u32 v19, v20, 5, v19
    v_and_b32 v20, 3, v16
    v_lshl_add_u32 v19, v20, 3, v19
    v_add_u32 v6, 16384, v19
    v_xor_b32 v7, 32, v6
    v_xor_b32 v8, 64, v6
    v_xor_b32 v9, 96, v6
    v_xor_b32 v10, 128, v6
    v_xor_b32 v11, 160, v6
    v_xor_b32 v12, 192, v6
    v_xor_b32 v13, 224, v6
    v_mov_b32 v128, 0
    v_mov_b32 v129, 0
    v_mov_b32 v130, 0
    v_mov_b32 v131, 0
    v_mov_b32 v132, 0
    v_mov_b32 v133, 0
    v_mov_b32 v134, 0
    v_mov_b32 v135, 0
    v_mov_b32 v136, 0
    v_mov_b32 v137, 0
    v_mov_b32 v138, 0
    v_mov_b32 v139, 0
    v_mov_b32 v140, 0
    v_mov_b32 v141, 0
    v_mov_b32 v142, 0
    v_mov_b32 v143, 0
    v_mov_b32 v144, 0
    v_mov_b32 v145, 0
    v_mov_b32 v146, 0
    v_mov_b32 v147, 0
    v_mov_b32 v148, 0
    v_mov_b32 v149, 0
    v_mov_b32 v150, 0
    v_mov_b32 v151, 0
    v_mov_b32 v152, 0
    v_mov_b32 v153, 0
    v_mov_b32 v154, 0
    v_mov_b32 v155, 0
    v_mov_b32 v156, 0
    v_mov_b32 v157, 0
    v_mov_b32 v158, 0
    v_mov_b32 v159, 0
    v_mov_b32 v160, 0
    v_mov_b32 v161, 0
    v_mov_b32 v162, 0
    v_mov_b32 v163, 0
    v_mov_b32 v164, 0
    v_mov_b32 v165, 0
    v_mov_b32 v166, 0
    v_mov_b32 v167, 0
    v_mov_b32 v168, 0
    v_mov_b32 v169, 0
    v_mov_b32 v170, 0
    v_mov_b32 v171, 0
    v_mov_b32 v172, 0
    v_mov_b32 v173, 0
    v_mov_b32 v174, 0
    v_mov_b32 v175, 0
    v_mov_b32 v176, 0
    v_mov_b32 v177, 0
    v_mov_b32 v178, 0
    v_mov_b32 v179, 0
    v_mov_b32 v180, 0
    v_mov_b32 v181, 0
    v_mov_b32 v182, 0
    v_mov_b32 v183, 0
    v_mov_b32 v184, 0
    v_mov_b32 v185, 0
    v_mov_b32 v186, 0
    v_mov_b32 v187, 0
    v_mov_b32 v188, 0
    v_mov_b32 v189, 0
    v_mov_b32 v190, 0
    v_mov_b32 v191, 0
    v_mov_b32 v192, 0
    v_mov_b32 v193, 0
    v_mov_b32 v194, 0
    v_mov_b32 v195, 0
    v_mov_b32 v196, 0
    v_mov_b32 v197, 0
    v_mov_b32 v198, 0
    v_mov_b32 v199, 0
    v_mov_b32 v200, 0
    v_mov_b32 v201, 0
    v_mov_b32 v202, 0
    v_mov_b32 v203, 0
    v_mov_b32 v204, 0
    v_mov_b32 v205, 0
    v_mov_b32 v206, 0
    v_mov_b32 v207, 0
    v_mov_b32 v208, 0
    v_mov_b32 v209, 0
    v_mov_b32 v210, 0
    v_mov_b32 v211, 0
    v_mov_b32 v212, 0
    v_mov_b32 v213, 0
    v_mov_b32 v214, 0
    v_mov_b32 v215, 0
    v_mov_b32 v216, 0
    v_mov_b32 v217, 0
    v_mov_b32 v218, 0
    v_mov_b32 v219, 0
    v_mov_b32 v220, 0
    v_mov_b32 v221, 0
    v_mov_b32 v222, 0
    v_mov_b32 v223, 0
    v_mov_b32 v224, 0
    v_mov_b32 v225, 0
    v_mov_b32 v226, 0
    v_mov_b32 v227, 0
    v_mov_b32 v228, 0
    v_mov_b32 v229, 0
    v_mov_b32 v230, 0
    v_mov_b32 v231, 0
    v_mov_b32 v232, 0
    v_mov_b32 v233, 0
    v_mov_b32 v234, 0
    v_mov_b32 v235, 0
    v_mov_b32 v236, 0
    v_mov_b32 v237, 0
    v_mov_b32 v238, 0
    v_mov_b32 v239, 0
    v_mov_b32 v240, 0
    v_mov_b32 v241, 0
    v_mov_b32 v242, 0
    v_mov_b32 v243, 0
    v_mov_b32 v244, 0
    v_mov_b32 v245, 0
    v_mov_b32 v246, 0
    v_mov_b32 v247, 0
    s_mov_b32 s80, 0
    s_mov_b32 s81, 0
    s_mov_b32 s82, 49152
    s_waitcnt lgkmcnt(0)
    s_add_u32 s28, s28, 0x9e3779b9
    s_mul_i32 s60, s77, 5
    s_and_b32 s61, s29, 2
    s_add_u32 s60, s60, s61
    s_mul_i32 s60, s60, 69632
    s_add_u32 s60, s60, 3670016
    s_add_u32 s44, s26, s60
    s_addc_u32 s45, s27, 0
    s_and_b32 s45, s45, 0xffff
    s_mov_b32 s46, 0x22000
    s_mov_b32 s47, 0x20000
    s_mov_b32 s52, s8
    s_and_b32 s53, s9, 0xffff
    s_mov_b32 s54, 0xc8000
    s_mov_b32 s55, 0x20000
    v_lshlrev_b32 v252, 7, v1
    s_lshl_b32 s60, s70, 3
    s_add_u32 s60, s60, s71
    s_lshl_b32 s60, s60, 2
    s_add_u32 s60, s60, s29
    s_mul_i32 s83, s60, 8192
    s_add_u32 s74, s83, 8192
    s_mul_i32 s75, s60, 1664
    s_and_b32 s79, s31, 7
    s_mul_i32 s79, s79, 4
    s_lshr_b32 s79, s79, 2
    s_add_u32 s79, s79, 1
    s_barrier
    ds_read_b128 v[96:99], v4 offset:0
    ds_read_b128 v[100:103], v4 offset:2048
    ds_read_b64_tr_b16 v[64:65], v6 offset:0
    ds_read_b64_tr_b16 v[66:67], v6 offset:2048
    ds_read_b64_tr_b16 v[68:69], v7 offset:0
    ds_read_b64_tr_b16 v[70:71], v7 offset:2048
    ds_read_b64_tr_b16 v[72:73], v8 offset:0
    ds_read_b64_tr_b16 v[74:75], v8 offset:2048
    ds_read_b64_tr_b16 v[76:77], v9 offset:0
    ds_read_b64_tr_b16 v[78:79], v9 offset:2048
    ds_read_b64_tr_b16 v[80:81], v10 offset:0
    ds_read_b64_tr_b16 v[82:83], v10 offset:2048
L_A_loop:
    s_cmp_lg_u32 s80, s79
    s_cbranch_scc1 L_A_nt2
    buffer_load_dword v253, v252, s[48:51], s83 offen
    s_mov_b32 exec_hi, 0
    s_mov_b32 exec_lo, 0x1fff
    s_mov_b64 exec, -1
L_A_nt2:
    s_waitcnt lgkmcnt(6)
    v_mfma_f32_16x16x32_bf16 v[128:131], v[64:67], v[96:99], v[128:131]
    ds_read_b64_tr_b16 v[84:85], v11 offset:0
    v_mfma_f32_16x16x32_bf16 v[132:135], v[64:67], v[100:103], v[132:135]
    ds_read_b64_tr_b16 v[86:87], v11 offset:2048
    v_mfma_f32_16x16x32_bf16 v[136:139], v[68:71], v[96:99], v[136:139]
    ds_read_b64_tr_b16 v[64:65], v12 offset:0
    v_mfma_f32_16x16x32_bf16 v[140:143], v[68:71], v[100:103], v[140:143]
    ds_read_b64_tr_b16 v[66:67], v12 offset:2048
    s_waitcnt lgkmcnt(6)
    v_mfma_f32_16x16x32_bf16 v[144:147], v[72:75], v[96:99], v[144:147]
    ds_read_b64_tr_b16 v[68:69], v13 offset:0
    v_mfma_f32_16x16x32_bf16 v[148:151], v[72:75], v[100:103], v[148:151]
    ds_read_b64_tr_b16 v[70:71], v13 offset:2048
    v_mfma_f32_16x16x32_bf16 v[152:155], v[76:79], v[96:99], v[152:155]
    ds_read_b64_tr_b16 v[72:73], v6 offset:256
    v_mfma_f32_16x16x32_bf16 v[156:159], v[76:79], v[100:103], v[156:159]
    ds_read_b64_tr_b16 v[74:75], v6 offset:2304
    s_waitcnt lgkmcnt(6)
    v_mfma_f32_16x16x32_bf16 v[160:163], v[80:83], v[96:99], v[160:163]
    ds_read_b64_tr_b16 v[76:77], v7 offset:256
    v_mfma_f32_16x16x32_bf16 v[164:167], v[80:83], v[100:103], v[164:167]
    ds_read_b64_tr_b16 v[78:79], v7 offset:2304
    v_mfma_f32_16x16x32_bf16 v[168:171], v[96:99], v[84:87], v[168:171]
    ds_read_b64_tr_b16 v[80:81], v8 offset:256
    v_mfma_f32_16x16x32_bf16 v[172:175], v[100:103], v[84:87], v[172:175]
    ds_read_b64_tr_b16 v[82:83], v8 offset:2304
    s_waitcnt lgkmcnt(6)
    v_mfma_f32_16x16x32_bf16 v[176:179], v[96:99], v[64:67], v[176:179]
    ds_read_b64_tr_b16 v[84:85], v9 offset:256
    v_mfma_f32_16x16x32_bf16 v[180:183], v[100:103], v[64:67], v[180:183]
    ds_read_b64_tr_b16 v[86:87], v9 offset:2304
    v_mfma_f32_16x16x32_bf16 v[184:187], v[96:99], v[68:71], v[184:187]
    ds_read_b64_tr_b16 v[64:65], v10 offset:256
    v_mfma_f32_16x16x32_bf16 v[188:191], v[100:103], v[68:71], v[188:191]
    ds_read_b64_tr_b16 v[66:67], v10 offset:2304
    s_waitcnt lgkmcnt(6)
    v_mfma_f32_16x16x32_bf16 v[192:195], v[96:99], v[72:75], v[192:195]
    ds_read_b128 v[104:107], v5 offset:0
    ds_read_b128 v[108:111], v5 offset:2048
    v_mfma_f32_16x16x32_bf16 v[196:199], v[100:103], v[72:75], v[196:199]
    ds_read_b64_tr_b16 v[68:69], v11 offset:256
    ds_read_b64_tr_b16 v[70:71], v11 offset:2304
    v_mfma_f32_16x16x32_bf16 v[200:203], v[96:99], v[76:79], v[200:203]
    ds_read_b64_tr_b16 v[72:73], v12 offset:256
    v_mfma_f32_16x16x32_bf16 v[204:207], v[100:103], v[76:79], v[204:207]
    ds_read_b64_tr_b16 v[74:75], v12 offset:2304
    s_waitcnt lgkmcnt(8)
    v_mfma_f32_16x16x32_bf16 v[208:211], v[96:99], v[80:83], v[208:211]
    ds_read_b64_tr_b16 v[76:77], v6 offset:16384
    v_mfma_f32_16x16x32_bf16 v[212:215], v[100:103], v[80:83], v[212:215]
    ds_read_b64_tr_b16 v[78:79], v6 offset:18432
    v_mfma_f32_16x16x32_bf16 v[216:219], v[96:99], v[84:87], v[216:219]
    ds_read_b64_tr_b16 v[80:81], v7 offset:16384
    v_mfma_f32_16x16x32_bf16 v[220:223], v[100:103], v[84:87], v[220:223]
    ds_read_b64_tr_b16 v[82:83], v7 offset:18432
    s_waitcnt lgkmcnt(6)
    v_mfma_f32_16x16x32_bf16 v[224:227], v[96:99], v[64:67], v[224:227]
    ds_read_b64_tr_b16 v[84:85], v8 offset:16384
    v_mfma_f32_16x16x32_bf16 v[228:231], v[100:103], v[64:67], v[228:231]
    ds_read_b64_tr_b16 v[86:87], v8 offset:18432
    v_mfma_f32_16x16x32_bf16 v[232:235], v[96:99], v[68:71], v[232:235]
    ds_read_b64_tr_b16 v[64:65], v9 offset:16384
    v_mfma_f32_16x16x32_bf16 v[236:239], v[100:103], v[68:71], v[236:239]
    ds_read_b64_tr_b16 v[66:67], v9 offset:18432
    s_waitcnt lgkmcnt(6)
    v_mfma_f32_16x16x32_bf16 v[240:243], v[96:99], v[72:75], v[240:243]
    ds_read_b64_tr_b16 v[68:69], v10 offset:16384
    v_mfma_f32_16x16x32_bf16 v[244:247], v[100:103], v[72:75], v[244:247]
    ds_read_b64_tr_b16 v[70:71], v10 offset:18432
    v_mfma_f32_16x16x32_bf16 v[128:131], v[76:79], v[104:107], v[128:131]
    ds_read_b64_tr_b16 v[72:73], v11 offset:16384
    v_mfma_f32_16x16x32_bf16 v[132:135], v[76:79], v[108:111], v[132:135]
    ds_read_b64_tr_b16 v[74:75], v11 offset:18432
    s_waitcnt lgkmcnt(6)
    v_mfma_f32_16x16x32_bf16 v[136:139], v[80:83], v[104:107], v[136:139]
    ds_read_b64_tr_b16 v[76:77], v12 offset:16384
    v_mfma_f32_16x16x32_bf16 v[140:143], v[80:83], v[108:111], v[140:143]
    ds_read_b64_tr_b16 v[78:79], v12 offset:18432
    v_mfma_f32_16x16x32_bf16 v[144:147], v[84:87], v[104:107], v[144:147]
    ds_read_b64_tr_b16 v[80:81], v13 offset:16384
    v_mfma_f32_16x16x32_bf16 v[148:151], v[84:87], v[108:111], v[148:151]
    ds_read_b64_tr_b16 v[82:83], v13 offset:18432
    s_waitcnt lgkmcnt(6)
    v_mfma_f32_16x16x32_bf16 v[152:155], v[64:67], v[104:107], v[152:155]
    ds_read_b64_tr_b16 v[84:85], v6 offset:16640
    v_mfma_f32_16x16x32_bf16 v[156:159], v[64:67], v[108:111], v[156:159]
    ds_read_b64_tr_b16 v[86:87], v6 offset:18688
    v_mfma_f32_16x16x32_bf16 v[160:163], v[68:71], v[104:107], v[160:163]
    ds_read_b64_tr_b16 v[64:65], v7 offset:16640
    v_mfma_f32_16x16x32_bf16 v[164:167], v[68:71], v[108:111], v[164:167]
    ds_read_b64_tr_b16 v[66:67], v7 offset:18688
    s_waitcnt lgkmcnt(6)
    v_mfma_f32_16x16x32_bf16 v[168:171], v[104:107], v[72:75], v[168:171]
    ds_read_b64_tr_b16 v[68:69], v8 offset:16640
    v_mfma_f32_16x16x32_bf16 v[172:175], v[108:111], v[72:75], v[172:175]
    ds_read_b64_tr_b16 v[70:71], v8 offset:18688
    v_mfma_f32_16x16x32_bf16 v[176:179], v[104:107], v[76:79], v[176:179]
    ds_read_b64_tr_b16 v[72:73], v9 offset:16640
    v_mfma_f32_16x16x32_bf16 v[180:183], v[108:111], v[76:79], v[180:183]
    ds_read_b64_tr_b16 v[74:75], v9 offset:18688
    s_waitcnt lgkmcnt(6)
    v_mfma_f32_16x16x32_bf16 v[184:187], v[104:107], v[80:83], v[184:187]
    ds_read_b64_tr_b16 v[76:77], v10 offset:16640
    v_mfma_f32_16x16x32_bf16 v[188:191], v[108:111], v[80:83], v[188:191]
    ds_read_b64_tr_b16 v[78:79], v10 offset:18688
    v_mfma_f32_16x16x32_bf16 v[192:195], v[104:107], v[84:87], v[192:195]
    ds_read_b64_tr_b16 v[80:81], v11 offset:16640
    v_mfma_f32_16x16x32_bf16 v[196:199], v[108:111], v[84:87], v[196:199]
    ds_read_b64_tr_b16 v[82:83], v11 offset:18688
    s_waitcnt lgkmcnt(6)
    v_mfma_f32_16x16x32_bf16 v[200:203], v[104:107], v[64:67], v[200:203]
    ds_read_b64_tr_b16 v[84:85], v12 offset:16640
    v_mfma_f32_16x16x32_bf16 v[204:207], v[108:111], v[64:67], v[204:207]
    ds_read_b64_tr_b16 v[86:87], v12 offset:18688
    v_mfma_f32_16x16x32_bf16 v[208:211], v[104:107], v[68:71], v[208:211]
    s_add_u32 s81, s81, 1
    s_cmp_eq_u32 s81, 3
    s_cselect_b32 s81, 0, s81
    s_cselect_b32 s60, 0xfffe8000, s82
    v_mfma_f32_16x16x32_bf16 v[212:215], v[108:111], v[68:71], v[212:215]
    v_add_u32 v4, s60, v4
    v_add_u32 v5, s60, v5
    v_add_u32 v6, s60, v6
    s_waitcnt lgkmcnt(4)
    v_mfma_f32_16x16x32_bf16 v[216:219], v[104:107], v[72:75], v[216:219]
    v_add_u32 v7, s60, v7
    v_add_u32 v8, s60, v8
    v_add_u32 v9, s60, v9
    v_add_u32 v10, s60, v10
    v_mfma_f32_16x16x32_bf16 v[220:223], v[108:111], v[72:75], v[220:223]
    v_add_u32 v11, s60, v11
    v_add_u32 v12, s60, v12
    v_add_u32 v13, s60, v13
    s_waitcnt lgkmcnt(0)
    s_barrier
    v_mfma_f32_16x16x32_bf16 v[224:227], v[104:107], v[76:79], v[224:227]
    ds_read_b128 v[96:99], v4 offset:0
    ds_read_b128 v[100:103], v4 offset:2048
    v_mfma_f32_16x16x32_bf16 v[228:231], v[108:111], v[76:79], v[228:231]
    ds_read_b64_tr_b16 v[64:65], v6 offset:0
    ds_read_b64_tr_b16 v[66:67], v6 offset:2048
    v_mfma_f32_16x16x32_bf16 v[232:235], v[104:107], v[80:83], v[232:235]
    ds_read_b64_tr_b16 v[68:69], v7 offset:0
    ds_read_b64_tr_b16 v[70:71], v7 offset:2048
    v_mfma_f32_16x16x32_bf16 v[236:239], v[108:111], v[80:83], v[236:239]
    ds_read_b64_tr_b16 v[72:73], v8 offset:0
    ds_read_b64_tr_b16 v[74:75], v8 offset:2048
    v_mfma_f32_16x16x32_bf16 v[240:243], v[104:107], v[84:87], v[240:243]
    ds_read_b64_tr_b16 v[76:77], v9 offset:0
    ds_read_b64_tr_b16 v[78:79], v9 offset:2048
    v_mfma_f32_16x16x32_bf16 v[244:247], v[108:111], v[84:87], v[244:247]
    ds_read_b64_tr_b16 v[80:81], v10 offset:0
    ds_read_b64_tr_b16 v[82:83], v10 offset:2048
    s_add_u32 s80, s80, 1
    s_cmp_lt_u32 s80, 10
    s_cbranch_scc1 L_A_loop
L_A_tail:
    s_mov_b32 s90, 0x3fb8aa3b
    s_mov_b32 s91, 0x3fb8aa3b
    s_mov_b32 s92, 0x358637bd
    s_mul_i32 s60, s29, 14336
    s_add_u32 s60, s60, 106496
    v_lshlrev_b32 v4, 4, v1
    v_add_u32 v4, s60, v4
    v_and_b32 v5, 15, v1
    v_lshlrev_b32 v5, 2, v5
    v_add_u32 v5, s60, v5
    v_mov_b32 v56, 0x3f803f80
    v_mov_b32 v57, 0x3f803f80
    v_mov_b32 v58, 0x3f803f80
    v_mov_b32 v59, 0x3f803f80
    v_cvt_pk_bf16_f32 v36, v208, v209
    v_cvt_pk_bf16_f32 v37, v210, v211
    v_cvt_pk_bf16_f32 v38, v212, v213
    v_cvt_pk_bf16_f32 v39, v214, v215
    v_cvt_pk_bf16_f32 v40, v216, v217
    v_cvt_pk_bf16_f32 v41, v218, v219
    v_cvt_pk_bf16_f32 v42, v220, v221
    v_cvt_pk_bf16_f32 v43, v222, v223
    v_cvt_pk_bf16_f32 v44, v224, v225
    v_cvt_pk_bf16_f32 v45, v226, v227
    v_cvt_pk_bf16_f32 v46, v228, v229
    v_cvt_pk_bf16_f32 v47, v230, v231
    v_cvt_pk_bf16_f32 v48, v232, v233
    v_cvt_pk_bf16_f32 v49, v234, v235
    v_cvt_pk_bf16_f32 v50, v236, v237
    v_cvt_pk_bf16_f32 v51, v238, v239
    v_cvt_pk_bf16_f32 v52, v240, v241
    v_cvt_pk_bf16_f32 v53, v242, v243
    v_cvt_pk_bf16_f32 v54, v244, v245
    v_cvt_pk_bf16_f32 v55, v246, v247
    s_waitcnt lgkmcnt(0)
    v_pk_mul_f32 v[60:61], v[168:169], s[90:91]
    v_pk_mul_f32 v[62:63], v[170:171], s[90:91]
    v_exp_f32_e64 v60, v60 clamp
    v_exp_f32_e64 v61, v61 clamp
    v_exp_f32_e64 v62, v62 clamp
    v_exp_f32_e64 v63, v63 clamp
    v_max_f32 v168, s92, v168
    v_max_f32 v169, s92, v169
    v_max_f32 v170, s92, v170
    v_max_f32 v171, s92, v171
    v_pk_add_f32 v[168:169], v[168:169], v[60:61]
    v_pk_add_f32 v[170:171], v[170:171], v[62:63]
    v_pk_mul_f32 v[60:61], v[172:173], s[90:91]
    v_pk_mul_f32 v[62:63], v[174:175], s[90:91]
    v_exp_f32_e64 v60, v60 clamp
    v_exp_f32_e64 v61, v61 clamp
    v_exp_f32_e64 v62, v62 clamp
    v_exp_f32_e64 v63, v63 clamp
    v_max_f32 v172, s92, v172
    v_max_f32 v173, s92, v173
    v_max_f32 v174, s92, v174
    v_max_f32 v175, s92, v175
    v_pk_add_f32 v[172:173], v[172:173], v[60:61]
    v_pk_add_f32 v[174:175], v[174:175], v[62:63]
    v_pk_mul_f32 v[60:61], v[176:177], s[90:91]
    v_pk_mul_f32 v[62:63], v[178:179], s[90:91]
    v_exp_f32_e64 v60, v60 clamp
    v_exp_f32_e64 v61, v61 clamp
    v_exp_f32_e64 v62, v62 clamp
    v_exp_f32_e64 v63, v63 clamp
    v_max_f32 v176, s92, v176
    v_max_f32 v177, s92, v177
    v_max_f32 v178, s92, v178
    v_max_f32 v179, s92, v179
    v_pk_add_f32 v[176:177], v[176:177], v[60:61]
    v_pk_add_f32 v[178:179], v[178:179], v[62:63]
    v_pk_mul_f32 v[60:61], v[180:181], s[90:91]
    v_pk_mul_f32 v[62:63], v[182:183], s[90:91]
    v_exp_f32_e64 v60, v60 clamp
    v_exp_f32_e64 v61, v61 clamp
    v_exp_f32_e64 v62, v62 clamp
    v_exp_f32_e64 v63, v63 clamp
    v_max_f32 v180, s92, v180
    v_max_f32 v181, s92, v181
    v_max_f32 v182, s92, v182
    v_max_f32 v183, s92, v183
    v_pk_add_f32 v[180:181], v[180:181], v[60:61]
    v_pk_add_f32 v[182:183], v[182:183], v[62:63]
    v_pk_mul_f32 v[60:61], v[184:185], s[90:91]
    v_pk_mul_f32 v[62:63], v[186:187], s[90:91]
    v_exp_f32_e64 v60, v60 clamp
    v_exp_f32_e64 v61, v61 clamp
    v_exp_f32_e64 v62, v62 clamp
    v_exp_f32_e64 v63, v63 clamp
    v_max_f32 v184, s92, v184
    v_max_f32 v185, s92, v185
    v_max_f32 v186, s92, v186
    v_max_f32 v187, s92, v187
    v_pk_add_f32 v[184:185], v[184:185], v[60:61]
    v_pk_add_f32 v[186:187], v[186:187], v[62:63]
    v_pk_mul_f32 v[60:61], v[188:189], s[90:91]
    v_pk_mul_f32 v[62:63], v[190:191], s[90:91]
    v_exp_f32_e64 v60, v60 clamp
    v_exp_f32_e64 v61, v61 clamp
    v_exp_f32_e64 v62, v62 clamp
    v_exp_f32_e64 v63, v63 clamp
    v_max_f32 v188, s92, v188
    v_max_f32 v189, s92, v189
    v_max_f32 v190, s92, v190
    v_max_f32 v191, s92, v191
    v_pk_add_f32 v[188:189], v[188:189], v[60:61]
    v_pk_add_f32 v[190:191], v[190:191], v[62:63]
    v_pk_mul_f32 v[60:61], v[192:193], s[90:91]
    v_pk_mul_f32 v[62:63], v[194:195], s[90:91]
    v_exp_f32_e64 v60, v60 clamp
    v_exp_f32_e64 v61, v61 clamp
    v_exp_f32_e64 v62, v62 clamp
    v_exp_f32_e64 v63, v63 clamp
    v_max_f32 v192, s92, v192
    v_max_f32 v193, s92, v193
    v_max_f32 v194, s92, v194
    v_max_f32 v195, s92, v195
    v_pk_add_f32 v[192:193], v[192:193], v[60:61]
    v_pk_add_f32 v[194:195], v[194:195], v[62:63]
    v_pk_mul_f32 v[60:61], v[196:197], s[90:91]
    v_pk_mul_f32 v[62:63], v[198:199], s[90:91]
    v_exp_f32_e64 v60, v60 clamp
    v_exp_f32_e64 v61, v61 clamp
    v_exp_f32_e64 v62, v62 clamp
    v_exp_f32_e64 v63, v63 clamp
    v_max_f32 v196, s92, v196
    v_max_f32 v197, s92, v197
    v_max_f32 v198, s92, v198
    v_max_f32 v199, s92, v199
    v_pk_add_f32 v[196:197], v[196:197], v[60:61]
    v_pk_add_f32 v[198:199], v[198:199], v[62:63]
    v_pk_mul_f32 v[60:61], v[200:201], s[90:91]
    v_pk_mul_f32 v[62:63], v[202:203], s[90:91]
    v_exp_f32_e64 v60, v60 clamp
    v_exp_f32_e64 v61, v61 clamp
    v_exp_f32_e64 v62, v62 clamp
    v_exp_f32_e64 v63, v63 clamp
    v_max_f32 v200, s92, v200
    v_max_f32 v201, s92, v201
    v_max_f32 v202, s92, v202
    v_max_f32 v203, s92, v203
    v_pk_add_f32 v[200:201], v[200:201], v[60:61]
    v_pk_add_f32 v[202:203], v[202:203], v[62:63]
    v_pk_mul_f32 v[60:61], v[204:205], s[90:91]
    v_pk_mul_f32 v[62:63], v[206:207], s[90:91]
    v_exp_f32_e64 v60, v60 clamp
    v_exp_f32_e64 v61, v61 clamp
    v_exp_f32_e64 v62, v62 clamp
    v_exp_f32_e64 v63, v63 clamp
    v_max_f32 v204, s92, v204
    v_max_f32 v205, s92, v205
    v_max_f32 v206, s92, v206
    v_max_f32 v207, s92, v207
    v_pk_add_f32 v[204:205], v[204:205], v[60:61]
    v_pk_add_f32 v[206:207], v[206:207], v[62:63]
    v_cvt_pk_bf16_f32 v16, v168, v169
    v_cvt_pk_bf16_f32 v17, v170, v171
    v_cvt_pk_bf16_f32 v18, v172, v173
    v_cvt_pk_bf16_f32 v19, v174, v175
    v_cvt_pk_bf16_f32 v20, v176, v177
    v_cvt_pk_bf16_f32 v21, v178, v179
    v_cvt_pk_bf16_f32 v22, v180, v181
    v_cvt_pk_bf16_f32 v23, v182, v183
    v_cvt_pk_bf16_f32 v24, v184, v185
    v_cvt_pk_bf16_f32 v25, v186, v187
    v_cvt_pk_bf16_f32 v26, v188, v189
    v_cvt_pk_bf16_f32 v27, v190, v191
    v_cvt_pk_bf16_f32 v28, v192, v193
    v_cvt_pk_bf16_f32 v29, v194, v195
    v_cvt_pk_bf16_f32 v30, v196, v197
    v_cvt_pk_bf16_f32 v31, v198, v199
    v_cvt_pk_bf16_f32 v32, v200, v201
    v_cvt_pk_bf16_f32 v33, v202, v203
    v_cvt_pk_bf16_f32 v34, v204, v205
    v_cvt_pk_bf16_f32 v35, v206, v207
    s_nop 1
    v_mfma_f32_16x16x32_bf16 v[64:67], v[16:19], v[36:39], 0
    v_mfma_f32_16x16x32_bf16 v[68:71], v[16:19], v[40:43], 0
    v_mfma_f32_16x16x32_bf16 v[208:211], v[56:59], v[16:19], 0
    v_mfma_f32_16x16x32_bf16 v[72:75], v[20:23], v[36:39], 0
    v_mfma_f32_16x16x32_bf16 v[76:79], v[20:23], v[40:43], 0
    v_mfma_f32_16x16x32_bf16 v[80:83], v[20:23], v[44:47], 0
    v_mfma_f32_16x16x32_bf16 v[212:215], v[56:59], v[20:23], 0
    v_mfma_f32_16x16x32_bf16 v[84:87], v[24:27], v[40:43], 0
    v_mfma_f32_16x16x32_bf16 v[88:91], v[24:27], v[44:47], 0
    v_mfma_f32_16x16x32_bf16 v[92:95], v[24:27], v[48:51], 0
    v_mfma_f32_16x16x32_bf16 v[216:219], v[56:59], v[24:27], 0
    v_mfma_f32_16x16x32_bf16 v[96:99], v[28:31], v[44:47], 0
    v_mfma_f32_16x16x32_bf16 v[100:103], v[28:31], v[48:51], 0
    v_mfma_f32_16x16x32_bf16 v[104:107], v[28:31], v[52:55], 0
    v_mfma_f32_16x16x32_bf16 v[220:223], v[56:59], v[28:31], 0
    ds_write_b128 v4, v[64:67] offset:0
    ds_write_b128 v4, v[68:71] offset:1024
    ds_write_b32 v5, v208 offset:13312
    v_mfma_f32_16x16x32_bf16 v[108:111], v[32:35], v[48:51], 0
    v_mfma_f32_16x16x32_bf16 v[112:115], v[32:35], v[52:55], 0
    v_mfma_f32_16x16x32_bf16 v[224:227], v[56:59], v[32:35], 0
    ds_write_b128 v4, v[72:75] offset:2048
    ds_write_b128 v4, v[76:79] offset:3072
    ds_write_b128 v4, v[80:83] offset:4096
    ds_write_b32 v5, v212 offset:13376
    ds_write_b128 v4, v[84:87] offset:5120
    ds_write_b128 v4, v[88:91] offset:6144
    ds_write_b128 v4, v[92:95] offset:7168
    ds_write_b32 v5, v216 offset:13440
    ds_write_b128 v4, v[96:99] offset:8192
    ds_write_b128 v4, v[100:103] offset:9216
    ds_write_b128 v4, v[104:107] offset:10240
    ds_write_b32 v5, v220 offset:13504
    ds_write_b128 v4, v[108:111] offset:11264
    ds_write_b128 v4, v[112:115] offset:12288
    ds_write_b32 v5, v224 offset:13568
    s_waitcnt lgkmcnt(0)
    s_barrier
    ds_read_b128 v[64:67], v2 offset:0
    ds_read_b128 v[68:71], v2 offset:14336
    ds_read_b128 v[72:75], v2 offset:28672
    ds_read_b128 v[76:79], v2 offset:43008
    s_lshl_b32 s60, s71, 4
    s_add_u32 s60, s60, s70
    s_mul_i32 s60, s60, 7168
    s_add_u32 s60, s60, 131072
    v_cmp_ne_u32 vcc, 0, v15
    s_waitcnt lgkmcnt(0)
    v_pk_add_f32 v[64:65], v[64:65], v[68:69]
    v_pk_add_f32 v[66:67], v[66:67], v[70:71]
    v_pk_add_f32 v[72:73], v[72:73], v[76:77]
    v_pk_add_f32 v[74:75], v[74:75], v[78:79]
    v_pk_add_f32 v[64:65], v[64:65], v[72:73]
    v_pk_add_f32 v[66:67], v[66:67], v[74:75]
    v_mov_b32_sdwa v64, s28 dst_sel:BYTE_0 dst_unused:UNUSED_PRESERVE src0_sel:BYTE_0
    v_mov_b32_sdwa v65, s28 dst_sel:BYTE_0 dst_unused:UNUSED_PRESERVE src0_sel:BYTE_1
    v_mov_b32_sdwa v66, s28 dst_sel:BYTE_0 dst_unused:UNUSED_PRESERVE src0_sel:BYTE_2
    v_mov_b32_sdwa v67, s28 dst_sel:BYTE_0 dst_unused:UNUSED_PRESERVE src0_sel:BYTE_3
    s_mov_b64 exec, vcc
    buffer_store_dwordx4 v[64:67], v14, s[32:35], s60 offen sc1
    s_mov_b64 exec, -1
    s_and_b32 s60, s29, 1
    s_mul_i32 s61, s60, 71680
    s_mul_i32 s60, s60, 0xfffef800
    s_add_u32 s60, s60, 69632
    v_lshlrev_b32 v12, 4, v1
    v_add_u32 v252, s60, v12
    v_add_u32 v12, s61, v12
    s_barrier
    s_mov_b32 s82, 49152
    buffer_load_dwordx4 v[172:175], v12, s[44:47], s82 offen offset:0 sc1
    buffer_load_dwordx4 v[176:179], v252, s[44:47], s82 offen offset:0 sc1
    buffer_load_dwordx4 v[180:183], v12, s[44:47], s82 offen offset:1024 sc1
    buffer_load_dwordx4 v[184:187], v252, s[44:47], s82 offen offset:1024 sc1
    s_mov_b32 s82, 53248
    buffer_load_dwordx4 v[188:191], v12, s[44:47], s82 offen offset:0 sc1
    buffer_load_dwordx4 v[192:195], v252, s[44:47], s82 offen offset:0 sc1
    buffer_load_dwordx4 v[196:199], v12, s[44:47], s82 offen offset:1024 sc1
    buffer_load_dwordx4 v[200:203], v252, s[44:47], s82 offen offset:1024 sc1
    s_mov_b32 s82, 57344
    buffer_load_dwordx4 v[204:207], v12, s[44:47], s82 offen offset:0 sc1
    buffer_load_dwordx4 v[208:211], v252, s[44:47], s82 offen offset:0 sc1
    buffer_load_dwordx4 v[212:215], v12, s[44:47], s82 offen offset:1024 sc1
    buffer_load_dwordx4 v[216:219], v252, s[44:47], s82 offen offset:1024 sc1
    s_mov_b32 s82, 61440
    buffer_load_dwordx4 v[220:223], v12, s[44:47], s82 offen offset:0 sc1
    buffer_load_dwordx4 v[224:227], v252, s[44:47], s82 offen offset:0 sc1
    buffer_load_dwordx4 v[228:231], v12, s[44:47], s82 offen offset:1024 sc1
    buffer_load_dwordx4 v[232:235], v252, s[44:47], s82 offen offset:1024 sc1
    s_mov_b32 s82, 65536
    buffer_load_dwordx4 v[236:239], v12, s[44:47], s82 offen offset:0 sc1
    buffer_load_dwordx4 v[240:243], v252, s[44:47], s82 offen offset:0 sc1
    buffer_load_dwordx4 v[244:247], v12, s[44:47], s82 offen offset:1024 sc1
    buffer_load_dwordx4 v[248:251], v252, s[44:47], s82 offen offset:1024 sc1
    v_pk_mul_f32 v[60:61], v[128:129], s[90:91]
    v_pk_mul_f32 v[62:63], v[130:131], s[90:91]
    v_exp_f32_e64 v60, v60 clamp
    v_exp_f32_e64 v61, v61 clamp
    v_exp_f32_e64 v62, v62 clamp
    v_exp_f32_e64 v63, v63 clamp
    v_max_f32 v128, s92, v128
    v_max_f32 v129, s92, v129
    v_max_f32 v130, s92, v130
    v_max_f32 v131, s92, v131
    v_pk_add_f32 v[128:129], v[128:129], v[60:61]
    v_pk_add_f32 v[130:131], v[130:131], v[62:63]
    v_pk_mul_f32 v[60:61], v[132:133], s[90:91]
    v_pk_mul_f32 v[62:63], v[134:135], s[90:91]
    v_exp_f32_e64 v60, v60 clamp
    v_exp_f32_e64 v61, v61 clamp
    v_exp_f32_e64 v62, v62 clamp
    v_exp_f32_e64 v63, v63 clamp
    v_max_f32 v132, s92, v132
    v_max_f32 v133, s92, v133
    v_max_f32 v134, s92, v134
    v_max_f32 v135, s92, v135
    v_pk_add_f32 v[132:133], v[132:133], v[60:61]
    v_pk_add_f32 v[134:135], v[134:135], v[62:63]
    v_pk_mul_f32 v[60:61], v[136:137], s[90:91]
    v_pk_mul_f32 v[62:63], v[138:139], s[90:91]
    v_exp_f32_e64 v60, v60 clamp
    v_exp_f32_e64 v61, v61 clamp
    v_exp_f32_e64 v62, v62 clamp
    v_exp_f32_e64 v63, v63 clamp
    v_max_f32 v136, s92, v136
    v_max_f32 v137, s92, v137
    v_max_f32 v138, s92, v138
    v_max_f32 v139, s92, v139
    v_pk_add_f32 v[136:137], v[136:137], v[60:61]
    v_pk_add_f32 v[138:139], v[138:139], v[62:63]
    v_pk_mul_f32 v[60:61], v[140:141], s[90:91]
    v_pk_mul_f32 v[62:63], v[142:143], s[90:91]
    v_exp_f32_e64 v60, v60 clamp
    v_exp_f32_e64 v61, v61 clamp
    v_exp_f32_e64 v62, v62 clamp
    v_exp_f32_e64 v63, v63 clamp
    v_max_f32 v140, s92, v140
    v_max_f32 v141, s92, v141
    v_max_f32 v142, s92, v142
    v_max_f32 v143, s92, v143
    v_pk_add_f32 v[140:141], v[140:141], v[60:61]
    v_pk_add_f32 v[142:143], v[142:143], v[62:63]
    v_pk_mul_f32 v[60:61], v[144:145], s[90:91]
    v_pk_mul_f32 v[62:63], v[146:147], s[90:91]
    v_exp_f32_e64 v60, v60 clamp
    v_exp_f32_e64 v61, v61 clamp
    v_exp_f32_e64 v62, v62 clamp
    v_exp_f32_e64 v63, v63 clamp
    v_max_f32 v144, s92, v144
    v_max_f32 v145, s92, v145
    v_max_f32 v146, s92, v146
    v_max_f32 v147, s92, v147
    v_pk_add_f32 v[144:145], v[144:145], v[60:61]
    v_pk_add_f32 v[146:147], v[146:147], v[62:63]
    v_pk_mul_f32 v[60:61], v[148:149], s[90:91]
    v_pk_mul_f32 v[62:63], v[150:151], s[90:91]
    v_exp_f32_e64 v60, v60 clamp
    v_exp_f32_e64 v61, v61 clamp
    v_exp_f32_e64 v62, v62 clamp
    v_exp_f32_e64 v63, v63 clamp
    v_max_f32 v148, s92, v148
    v_max_f32 v149, s92, v149
    v_max_f32 v150, s92, v150
    v_max_f32 v151, s92, v151
    v_pk_add_f32 v[148:149], v[148:149], v[60:61]
    v_pk_add_f32 v[150:151], v[150:151], v[62:63]
    v_pk_mul_f32 v[60:61], v[152:153], s[90:91]
    v_pk_mul_f32 v[62:63], v[154:155], s[90:91]
    v_exp_f32_e64 v60, v60 clamp
    v_exp_f32_e64 v61, v61 clamp
    v_exp_f32_e64 v62, v62 clamp
    v_exp_f32_e64 v63, v63 clamp
    v_max_f32 v152, s92, v152
    v_max_f32 v153, s92, v153
    v_max_f32 v154, s92, v154
    v_max_f32 v155, s92, v155
    v_pk_add_f32 v[152:153], v[152:153], v[60:61]
    v_pk_add_f32 v[154:155], v[154:155], v[62:63]
    v_pk_mul_f32 v[60:61], v[156:157], s[90:91]
    v_pk_mul_f32 v[62:63], v[158:159], s[90:91]
    v_exp_f32_e64 v60, v60 clamp
    v_exp_f32_e64 v61, v61 clamp
    v_exp_f32_e64 v62, v62 clamp
    v_exp_f32_e64 v63, v63 clamp
    v_max_f32 v156, s92, v156
    v_max_f32 v157, s92, v157
    v_max_f32 v158, s92, v158
    v_max_f32 v159, s92, v159
    v_pk_add_f32 v[156:157], v[156:157], v[60:61]
    v_pk_add_f32 v[158:159], v[158:159], v[62:63]
    v_pk_mul_f32 v[60:61], v[160:161], s[90:91]
    v_pk_mul_f32 v[62:63], v[162:163], s[90:91]
    v_exp_f32_e64 v60, v60 clamp
    v_exp_f32_e64 v61, v61 clamp
    v_exp_f32_e64 v62, v62 clamp
    v_exp_f32_e64 v63, v63 clamp
    v_max_f32 v160, s92, v160
    v_max_f32 v161, s92, v161
    v_max_f32 v162, s92, v162
    v_max_f32 v163, s92, v163
    v_pk_add_f32 v[160:161], v[160:161], v[60:61]
    v_pk_add_f32 v[162:163], v[162:163], v[62:63]
    v_pk_mul_f32 v[60:61], v[164:165], s[90:91]
    v_pk_mul_f32 v[62:63], v[166:167], s[90:91]
    v_exp_f32_e64 v60, v60 clamp
    v_exp_f32_e64 v61, v61 clamp
    v_exp_f32_e64 v62, v62 clamp
    v_exp_f32_e64 v63, v63 clamp
    v_max_f32 v164, s92, v164
    v_max_f32 v165, s92, v165
    v_max_f32 v166, s92, v166
    v_max_f32 v167, s92, v167
    v_pk_add_f32 v[164:165], v[164:165], v[60:61]
    v_pk_add_f32 v[166:167], v[166:167], v[62:63]
    v_cvt_pk_bf16_f32 v16, v128, v129
    v_cvt_pk_bf16_f32 v17, v130, v131
    v_cvt_pk_bf16_f32 v18, v136, v137
    v_cvt_pk_bf16_f32 v19, v138, v139
    v_cvt_pk_bf16_f32 v20, v132, v133
    v_cvt_pk_bf16_f32 v21, v134, v135
    v_cvt_pk_bf16_f32 v22, v140, v141
    v_cvt_pk_bf16_f32 v23, v142, v143
    v_cvt_pk_bf16_f32 v24, v144, v145
    v_cvt_pk_bf16_f32 v25, v146, v147
    v_cvt_pk_bf16_f32 v26, v152, v153
    v_cvt_pk_bf16_f32 v27, v154, v155
    v_cvt_pk_bf16_f32 v28, v148, v149
    v_cvt_pk_bf16_f32 v29, v150, v151
    v_cvt_pk_bf16_f32 v30, v156, v157
    v_cvt_pk_bf16_f32 v31, v158, v159
    v_cvt_pk_bf16_f32 v32, v160, v161
    v_cvt_pk_bf16_f32 v33, v162, v163
    v_mov_b32 v34, 0
    v_mov_b32 v35, 0
    v_cvt_pk_bf16_f32 v36, v164, v165
    v_cvt_pk_bf16_f32 v37, v166, v167
    v_mov_b32 v38, 0
    v_mov_b32 v39, 0
    s_mov_b32 s52, s18
    s_and_b32 s53, s19, 0xffff
    s_mov_b32 s54, 0x1000
    s_mov_b32 s55, 0x20000
    s_mov_b32 s56, s22
    s_and_b32 s57, s23, 0xffff
    s_mov_b32 s58, 0x280000
    s_mov_b32 s59, 0x20000
    v_and_b32 v9, 15, v1
    v_lshrrev_b32 v10, 4, v1
    v_lshrrev_b32 v11, 2, v9
    v_lshl_add_u32 v11, v10, 2, v11
    v_bfe_u32 v10, v11, 1, 2
    v_lshlrev_b32 v11, 7, v11
    v_lshl_add_u32 v11, v10, 5, v11
    v_and_b32 v9, 3, v9
    v_lshl_add_u32 v8, v9, 3, v11
    v_xor_b32 v9, 32, v8
    v_xor_b32 v10, 64, v8
    v_xor_b32 v11, 96, v8
    s_and_b32 s62, s29, 1
    s_mul_i32 s83, s77, 5
    s_add_u32 s83, s83, s29
    s_lshl_b32 s60, s62, 13
    v_add_u32 v42, s60, v8
    s_lshl_b32 s62, s62, 11
    v_lshlrev_b32 v51, 4, v1
    v_add_u32 v51, s62, v51
    v_add_u32 v13, 0x20000, v51
    v_and_b32 v47, 15, v1
    v_lshlrev_b32 v43, 1, v47
    v_lshlrev_b32 v47, 2, v47
    v_lshlrev_b32 v55, 3, v1
    v_add_u32 v55, s62, v55
    s_xor_b32 s72, s29, 0
    s_lshl_b32 s60, s72, 5
    v_xor_b32 v4, s60, v42
    s_lshl_b32 s61, s76, 7
    s_add_u32 s60, s60, s61
    buffer_load_ushort v168, v43, s[52:55], s60 offen
    v_add_u32 v8, 0x10000, v4
    s_lshl_b32 s60, s72, 12
    v_add_u32 v52, s60, v55
    s_add_u32 s60, s60, 0x10000
    v_add_u32 v48, s60, v51
    s_xor_b32 s73, s29, 1
    s_lshl_b32 s60, s73, 5
    v_xor_b32 v5, s60, v42
    s_lshl_b32 s61, s76, 7
    s_add_u32 s60, s60, s61
    buffer_load_ushort v169, v43, s[52:55], s60 offen
    v_add_u32 v9, 0x10000, v5
    s_lshl_b32 s60, s73, 12
    v_add_u32 v53, s60, v55
    s_add_u32 s60, s60, 0x10000
    v_add_u32 v49, s60, v51
    s_xor_b32 s74, s29, 2
    s_lshl_b32 s60, s74, 5
    v_xor_b32 v6, s60, v42
    s_lshl_b32 s61, s76, 7
    s_add_u32 s60, s60, s61
    buffer_load_ushort v170, v43, s[52:55], s60 offen
    v_add_u32 v10, 0x10000, v6
    s_lshl_b32 s60, s74, 12
    v_add_u32 v54, s60, v55
    s_add_u32 s60, s60, 0x10000
    v_add_u32 v50, s60, v51
    s_xor_b32 s75, s29, 3
    s_lshl_b32 s60, s75, 5
    v_xor_b32 v7, s60, v42
    s_lshl_b32 s61, s76, 7
    s_add_u32 s60, s60, s61
    buffer_load_ushort v171, v43, s[52:55], s60 offen
    v_add_u32 v11, 0x10000, v7
    s_lshl_b32 s60, s75, 12
    v_add_u32 v55, s60, v55
    s_add_u32 s60, s60, 0x10000
    v_add_u32 v51, s60, v51
    s_lshl_b32 s80, s76, 8
    s_add_u32 s80, s80, 73728
    s_lshl_b32 s79, s77, 1
    s_add_u32 s79, s79, s76
    s_and_b32 s79, s79, 7
    s_mov_b32 s66, 0x76543210
    s_mov_b32 s67, 0xba98
    s_cmp_eq_u32 s79, 0
    s_cselect_b32 s66, 0x76543102, s66
    s_cselect_b32 s67, 0xb98a, s67
    s_cmp_eq_u32 s79, 1
    s_cselect_b32 s66, 0x76542130, s66
    s_cselect_b32 s67, 0xa9b8, s67
    s_cmp_eq_u32 s79, 2
    s_cselect_b32 s66, 0x76532410, s66
    s_cselect_b32 s67, 0xba98, s67
    s_cmp_eq_u32 s79, 3
    s_cselect_b32 s66, 0x76435210, s66
    s_cselect_b32 s67, 0xba98, s67
    s_cmp_eq_u32 s79, 4
    s_cselect_b32 s66, 0x75463210, s66
    s_cselect_b32 s67, 0xba98, s67
    s_cmp_eq_u32 s79, 5
    s_cselect_b32 s66, 0x65743210, s66
    s_cselect_b32 s67, 0xba98, s67
    s_cmp_eq_u32 s79, 6
    s_cselect_b32 s66, 0x68543210, s66
    s_cselect_b32 s67, 0xba97, s67
    s_cmp_eq_u32 s79, 7
    s_cselect_b32 s66, 0x96543210, s66
    s_cselect_b32 s67, 0xba87, s67
    s_barrier
    v_and_b32 v63, 15, v1
    v_lshlrev_b32 v63, 2, v63
    s_lshl_b32 s60, s70, 7
    s_lshl_b32 s61, s29, 5
    s_add_u32 s60, s60, s61
    s_lshl_b32 s60, s60, 2
    s_add_u32 s60, s60, 73728
    buffer_load_dword v62, v63, s[32:35], s60 offen sc1
    buffer_load_dword v61, v63, s[32:35], s60 offen offset:64 sc1
    v_lshrrev_b32 v40, 4, v1
    v_cmp_gt_u32 s[84:85], 1, v40
    v_cmp_gt_u32 s[86:87], 2, v40
    v_cmp_gt_u32 s[88:89], 3, v40
    s_lshl_b32 s60, s70, 3
    s_lshl_b32 s61, s29, 1
    s_add_u32 s60, s60, s61
    s_mul_i32 s60, s60, 20480
    s_add_u32 s60, s60, 6553600
    s_lshl_b32 s93, s71, 11
    s_add_u32 s93, s93, s60
    s_lshl_b32 s79, s71, 9
    s_add_u32 s79, s79, s60
    s_add_u32 s79, s79, 16384
    v_lshlrev_b32 v40, 4, v1
    v_lshlrev_b32 v41, 3, v1
    v_add_u32 v60, 147456, v40
    s_call_b64 s[68:69], L_gather
    s_waitcnt lgkmcnt(0)
    s_barrier
    ds_read_b128 v[108:111], v60 offset:11264
    ds_read_b128 v[112:115], v60 offset:12288
    ds_read_b128 v[116:119], v60 offset:13312
    ds_read_b128 v[64:67], v60 offset:0
    ds_read_b128 v[72:75], v60 offset:2048
    ds_read_b128 v[76:79], v60 offset:3072
    ds_read_b128 v[80:83], v60 offset:4096
    ds_read_b128 v[84:87], v60 offset:5120
    ds_read_b128 v[92:95], v60 offset:7168
    ds_read_b128 v[96:99], v60 offset:8192
    ds_read_b128 v[100:103], v60 offset:9216
    ds_read_b128 v[104:107], v60 offset:10240
    s_waitcnt lgkmcnt(9)
    v_mfma_f32_16x16x32_bf16 v[120:123], v[108:111], v[16:19], 0
    v_mfma_f32_16x16x32_bf16 v[124:127], v[108:111], v[20:23], 0
    v_mfma_f32_16x16x32_bf16 v[120:123], v[112:115], v[24:27], v[120:123]
    v_mfma_f32_16x16x32_bf16 v[124:127], v[112:115], v[28:31], v[124:127]
    v_mfma_f32_16x16x32_bf16 v[120:123], v[116:119], v[32:35], v[120:123]
    v_mfma_f32_16x16x32_bf16 v[124:127], v[116:119], v[36:39], v[124:127]
    s_waitcnt lgkmcnt(0)
    v_mfma_f32_16x16x32_bf16 v[128:131], v[64:67], v[16:19], 0
    v_mfma_f32_16x16x32_bf16 v[132:135], v[72:75], v[16:19], 0
    v_mfma_f32_16x16x32_bf16 v[132:135], v[76:79], v[24:27], v[132:135]
    v_mfma_f32_16x16x32_bf16 v[136:139], v[80:83], v[16:19], 0
    v_mfma_f32_16x16x32_bf16 v[136:139], v[84:87], v[24:27], v[136:139]
    v_mfma_f32_16x16x32_bf16 v[140:143], v[92:95], v[24:27], 0
    v_mfma_f32_16x16x32_bf16 v[140:143], v[96:99], v[32:35], v[140:143]
    v_add_f32 v120, s92, v120
    v_add_f32 v121, s92, v121
    v_mfma_f32_16x16x32_bf16 v[144:147], v[100:103], v[24:27], 0
    v_add_f32 v122, s92, v122
    v_add_f32 v123, s92, v123
    v_mfma_f32_16x16x32_bf16 v[144:147], v[104:107], v[32:35], v[144:147]
    v_add_f32 v124, s92, v124
    v_add_f32 v125, s92, v125
    v_mfma_f32_16x16x32_bf16 v[148:151], v[64:67], v[20:23], 0
    v_add_f32 v126, s92, v126
    v_add_f32 v127, s92, v127
    v_mfma_f32_16x16x32_bf16 v[152:155], v[72:75], v[20:23], 0
    v_rcp_f32 v120, v120
    v_rcp_f32 v121, v121
    v_mfma_f32_16x16x32_bf16 v[152:155], v[76:79], v[28:31], v[152:155]
    v_rcp_f32 v122, v122
    v_rcp_f32 v123, v123
    v_mfma_f32_16x16x32_bf16 v[156:159], v[80:83], v[20:23], 0
    v_rcp_f32 v124, v124
    v_rcp_f32 v125, v125
    v_mfma_f32_16x16x32_bf16 v[156:159], v[84:87], v[28:31], v[156:159]
    v_rcp_f32 v126, v126
    v_rcp_f32 v127, v127
    v_mfma_f32_16x16x32_bf16 v[160:163], v[92:95], v[28:31], 0
    v_mul_f32 v120, v62, v120
    v_mul_f32 v121, v62, v121
    v_mfma_f32_16x16x32_bf16 v[160:163], v[96:99], v[36:39], v[160:163]
    v_mul_f32 v122, v62, v122
    v_mul_f32 v123, v62, v123
    v_mfma_f32_16x16x32_bf16 v[164:167], v[100:103], v[28:31], 0
    v_mul_f32 v124, v61, v124
    v_mul_f32 v125, v61, v125
    v_mfma_f32_16x16x32_bf16 v[164:167], v[104:107], v[36:39], v[164:167]
    v_mul_f32 v126, v61, v126
    v_mul_f32 v127, v61, v127
    v_cndmask_b32 v44, v121, v120, s[84:85]
    v_cndmask_b32 v45, v122, v121, s[86:87]
    v_cndmask_b32 v46, v123, v122, s[88:89]
    v_mul_f32 v128, v120, v128
    v_mul_f32 v129, v120, v129
    v_mul_f32 v130, v120, v130
    v_mul_f32 v131, v120, v131
    v_mul_f32 v132, v44, v132
    v_mul_f32 v133, v44, v133
    v_mul_f32 v134, v44, v134
    v_mul_f32 v135, v44, v135
    v_mul_f32 v136, v45, v136
    v_mul_f32 v137, v45, v137
    v_mul_f32 v138, v45, v138
    v_mul_f32 v139, v45, v139
    v_mul_f32 v140, v46, v140
    v_mul_f32 v141, v46, v141
    v_mul_f32 v142, v46, v142
    v_mul_f32 v143, v46, v143
    v_mul_f32 v144, v123, v144
    v_mul_f32 v145, v123, v145
    v_mul_f32 v146, v123, v146
    v_mul_f32 v147, v123, v147
    v_cvt_pk_bf16_f32 v16, v128, v129
    v_cvt_pk_bf16_f32 v17, v130, v131
    v_cvt_pk_bf16_f32 v18, v132, v133
    v_cvt_pk_bf16_f32 v19, v134, v135
    v_cvt_pk_bf16_f32 v20, v136, v137
    v_cvt_pk_bf16_f32 v21, v138, v139
    v_cvt_pk_bf16_f32 v22, v140, v141
    v_cvt_pk_bf16_f32 v23, v142, v143
    v_cvt_pk_bf16_f32 v24, v144, v145
    v_cvt_pk_bf16_f32 v25, v146, v147
    buffer_store_dwordx4 v[16:19], v40, s[32:35], s93 offen sc1
    buffer_store_dwordx4 v[20:23], v40, s[32:35], s93 offen offset:1024 sc1
    buffer_store_dwordx2 v[24:25], v41, s[32:35], s79 offen sc1
    s_add_u32 s93, s93, 20480
    s_add_u32 s79, s79, 20480
    v_cndmask_b32 v44, v125, v124, s[84:85]
    v_cndmask_b32 v45, v126, v125, s[86:87]
    v_cndmask_b32 v46, v127, v126, s[88:89]
    v_mul_f32 v148, v124, v148
    v_mul_f32 v149, v124, v149
    v_mul_f32 v150, v124, v150
    v_mul_f32 v151, v124, v151
    v_mul_f32 v152, v44, v152
    v_mul_f32 v153, v44, v153
    v_mul_f32 v154, v44, v154
    v_mul_f32 v155, v44, v155
    v_mul_f32 v156, v45, v156
    v_mul_f32 v157, v45, v157
    v_mul_f32 v158, v45, v158
    v_mul_f32 v159, v45, v159
    v_mul_f32 v160, v46, v160
    v_mul_f32 v161, v46, v161
    v_mul_f32 v162, v46, v162
    v_mul_f32 v163, v46, v163
    v_mul_f32 v164, v127, v164
    v_mul_f32 v165, v127, v165
    v_mul_f32 v166, v127, v166
    v_mul_f32 v167, v127, v167
    v_cvt_pk_bf16_f32 v28, v148, v149
    v_cvt_pk_bf16_f32 v29, v150, v151
    v_cvt_pk_bf16_f32 v30, v152, v153
    v_cvt_pk_bf16_f32 v31, v154, v155
    v_cvt_pk_bf16_f32 v32, v156, v157
    v_cvt_pk_bf16_f32 v33, v158, v159
    v_cvt_pk_bf16_f32 v34, v160, v161
    v_cvt_pk_bf16_f32 v35, v162, v163
    v_cvt_pk_bf16_f32 v36, v164, v165
    v_cvt_pk_bf16_f32 v37, v166, v167
    buffer_store_dwordx4 v[28:31], v40, s[32:35], s93 offen sc1
    buffer_store_dwordx4 v[32:35], v40, s[32:35], s93 offen offset:1024 sc1
    buffer_store_dwordx2 v[36:37], v41, s[32:35], s79 offen sc1
    s_branch L_F_comp
L_A_loader:
    s_mov_b32 s40, s6
    s_and_b32 s41, s7, 0xffff
    s_mov_b32 s42, 0x258000
    s_mov_b32 s43, 0x20000
    s_sub_u32 s83, s29, 4
    v_lshrrev_b32 v16, 3, v1
    v_lshrrev_b32 v17, 4, v1
    v_and_b32 v18, 7, v1
    v_xor_b32 v17, v17, v18
    v_lshlrev_b32 v17, 4, v17
    v_mul_u32_u24 v16, 1280, v16
    v_add_u32 v4, v16, v17
    v_xor_b32 v18, 64, v4
    v_add_u32 v5, 9216, v18
    v_add_u32 v6, 18432, v4
    v_add_u32 v7, 27648, v18
    s_lshl_b32 s60, s70, 7
    s_lshl_b32 s61, s83, 5
    s_add_u32 s60, s60, s61
    s_mul_i32 s80, s60, 1280
    s_lshl_b32 s82, s83, 12
    s_mov_b32 m0, s82
    s_nop 0
    buffer_load_dwordx4 v4, s[36:39], s80 offen offset:0 lds
    buffer_load_dwordx4 v5, s[36:39], s80 offen offset:1024 lds
    buffer_load_dwordx4 v6, s[36:39], s80 offen offset:2048 lds
    buffer_load_dwordx4 v7, s[36:39], s80 offen offset:3072 lds
    s_add_u32 s80, s80, 128
    v_lshrrev_b32 v16, 5, v1
    v_bfe_u32 v17, v1, 1, 4
    v_and_b32 v18, 1, v1
    v_lshlrev_b32 v18, 4, v18
    v_mul_u32_u24 v19, 3840, v16
    v_add_u32 v18, v18, v19
    s_and_b32 s60, s83, 1
    s_lshl_b32 s60, s60, 2
    v_or_b32 v16, s60, v16
    v_or_b32 v19, 0, v16
    v_xor_b32 v19, v17, v19
    v_min_u32 v19, 14, v19
    v_mul_u32_u24 v20, 13, v19
    v_lshrrev_b32 v20, 6, v20
    v_mul_u32_u24 v20, 1120, v20
    v_lshl_add_u32 v19, v19, 5, v20
    v_add_u32 v19, v19, v18
    v_add_u32 v8, 0, v19
    v_add_u32 v10, 13312, v19
    v_or_b32 v19, 2, v16
    v_xor_b32 v19, v17, v19
    v_min_u32 v19, 14, v19
    v_mul_u32_u24 v20, 13, v19
    v_lshrrev_b32 v20, 6, v20
    v_mul_u32_u24 v20, 1120, v20
    v_lshl_add_u32 v19, v19, 5, v20
    v_add_u32 v19, v19, v18
    v_add_u32 v9, 6656, v19
    v_add_u32 v11, 19968, v19
    s_mul_i32 s81, s71, 160
    s_mul_i32 s60, s83, 30720
    s_add_u32 s81, s81, s60
    s_add_u32 m0, s82, 16384
    s_add_u32 s60, s81, 0
    buffer_load_dwordx4 v8, s[40:43], s60 offen offset:0 lds
    buffer_load_dwordx4 v9, s[40:43], s60 offen offset:1024 lds
    buffer_load_dwordx4 v10, s[40:43], s60 offen offset:2048 lds
    buffer_load_dwordx4 v11, s[40:43], s60 offen offset:3072 lds
    s_add_u32 m0, s82, 32768
    s_add_u32 s60, s81, 122880
    buffer_load_dwordx4 v8, s[40:43], s60 offen offset:0 lds
    buffer_load_dwordx4 v9, s[40:43], s60 offen offset:1024 lds
    buffer_load_dwordx4 v10, s[40:43], s60 offen offset:2048 lds
    buffer_load_dwordx4 v11, s[40:43], s60 offen offset:3072 lds
    s_add_u32 s81, s81, 245760
    s_add_u32 s82, s82, 49152
    s_cmp_ge_u32 s82, 147456
    s_cselect_b32 s60, 147456, 0
    s_sub_u32 s82, s82, s60
    s_mov_b32 m0, s82
    s_nop 0
    buffer_load_dwordx4 v4, s[36:39], s80 offen offset:0 lds
    buffer_load_dwordx4 v5, s[36:39], s80 offen offset:1024 lds
    buffer_load_dwordx4 v6, s[36:39], s80 offen offset:2048 lds
    buffer_load_dwordx4 v7, s[36:39], s80 offen offset:3072 lds
    s_add_u32 s80, s80, 128
    s_add_u32 m0, s82, 16384
    s_add_u32 s60, s81, 0
    buffer_load_dwordx4 v8, s[40:43], s60 offen offset:0 lds
    buffer_load_dwordx4 v9, s[40:43], s60 offen offset:1024 lds
    buffer_load_dwordx4 v10, s[40:43], s60 offen offset:2048 lds
    buffer_load_dwordx4 v11, s[40:43], s60 offen offset:3072 lds
    s_add_u32 m0, s82, 32768
    s_add_u32 s60, s81, 122880
    buffer_load_dwordx4 v8, s[40:43], s60 offen offset:0 lds
    buffer_load_dwordx4 v9, s[40:43], s60 offen offset:1024 lds
    buffer_load_dwordx4 v10, s[40:43], s60 offen offset:2048 lds
    buffer_load_dwordx4 v11, s[40:43], s60 offen offset:3072 lds
    s_add_u32 s81, s81, 245760
    s_add_u32 s82, s82, 49152
    s_cmp_ge_u32 s82, 147456
    s_cselect_b32 s60, 147456, 0
    s_sub_u32 s82, s82, s60
    s_mov_b32 m0, s82
    s_nop 0
    buffer_load_dwordx4 v4, s[36:39], s80 offen offset:0 lds
    buffer_load_dwordx4 v5, s[36:39], s80 offen offset:1024 lds
    buffer_load_dwordx4 v6, s[36:39], s80 offen offset:2048 lds
    buffer_load_dwordx4 v7, s[36:39], s80 offen offset:3072 lds
    s_add_u32 s80, s80, 128
    s_add_u32 m0, s82, 16384
    s_add_u32 s60, s81, 0
    buffer_load_dwordx4 v8, s[40:43], s60 offen offset:0 lds
    buffer_load_dwordx4 v9, s[40:43], s60 offen offset:1024 lds
    buffer_load_dwordx4 v10, s[40:43], s60 offen offset:2048 lds
    buffer_load_dwordx4 v11, s[40:43], s60 offen offset:3072 lds
    s_add_u32 m0, s82, 32768
    s_add_u32 s60, s81, 122880
    buffer_load_dwordx4 v8, s[40:43], s60 offen offset:0 lds
    buffer_load_dwordx4 v9, s[40:43], s60 offen offset:1024 lds
    buffer_load_dwordx4 v10, s[40:43], s60 offen offset:2048 lds
    buffer_load_dwordx4 v11, s[40:43], s60 offen offset:3072 lds
    s_add_u32 s81, s81, 245760
    s_waitcnt lgkmcnt(0)
    s_add_u32 s28, s28, 0x9e3779b9
    s_waitcnt vmcnt(24)
    s_barrier
    s_lshl_b32 s79, s71, 1
    s_add_u32 s79, s79, s70
    s_and_b32 s79, s79, 7
    s_mov_b32 s66, 0x6543210
    s_mov_b32 s67, 0x0
    s_cmp_eq_u32 s79, 0
    s_cselect_b32 s66, 0x6543102, s66
    s_cselect_b32 s67, 0x0, s67
    s_cmp_eq_u32 s79, 1
    s_cselect_b32 s66, 0x6542130, s66
    s_cselect_b32 s67, 0x0, s67
    s_cmp_eq_u32 s79, 2
    s_cselect_b32 s66, 0x6532410, s66
    s_cselect_b32 s67, 0x0, s67
    s_cmp_eq_u32 s79, 3
    s_cselect_b32 s66, 0x6435210, s66
    s_cselect_b32 s67, 0x0, s67
    s_cmp_eq_u32 s79, 4
    s_cselect_b32 s66, 0x5463210, s66
    s_cselect_b32 s67, 0x0, s67
    s_cmp_eq_u32 s79, 5
    s_cselect_b32 s66, 0x6543210, s66
    s_cselect_b32 s67, 0x0, s67
    s_cmp_eq_u32 s79, 6
    s_cselect_b32 s66, 0x6543210, s66
    s_cselect_b32 s67, 0x0, s67
    s_cmp_eq_u32 s79, 7
    s_cselect_b32 s66, 0x6543210, s66
    s_cselect_b32 s67, 0x0, s67
    s_mov_b32 s74, s80
    s_mov_b32 s75, s81
    s_mov_b32 s78, 1
L_A_lloop:
    s_and_b32 s81, s66, 15
    s_lshr_b64 s[66:67], s[66:67], 4
    s_lshl_b32 s81, s81, 0
    s_lshl_b32 s80, s81, 7
    s_add_u32 s80, s80, s74
    s_mul_i32 s81, s81, 245760
    s_add_u32 s81, s81, s75
    s_waitcnt vmcnt(12)
    s_barrier
    s_add_u32 s82, s82, 49152
    s_cmp_ge_u32 s82, 147456
    s_cselect_b32 s60, 147456, 0
    s_sub_u32 s82, s82, s60
    s_mov_b32 m0, s82
    s_nop 0
    buffer_load_dwordx4 v4, s[36:39], s80 offen offset:0 lds
    buffer_load_dwordx4 v5, s[36:39], s80 offen offset:1024 lds
    buffer_load_dwordx4 v6, s[36:39], s80 offen offset:2048 lds
    buffer_load_dwordx4 v7, s[36:39], s80 offen offset:3072 lds
    s_add_u32 s80, s80, 128
    s_add_u32 m0, s82, 16384
    s_add_u32 s60, s81, 0
    buffer_load_dwordx4 v8, s[40:43], s60 offen offset:0 lds
    buffer_load_dwordx4 v9, s[40:43], s60 offen offset:1024 lds
    buffer_load_dwordx4 v10, s[40:43], s60 offen offset:2048 lds
    buffer_load_dwordx4 v11, s[40:43], s60 offen offset:3072 lds
    s_add_u32 m0, s82, 32768
    s_add_u32 s60, s81, 122880
    buffer_load_dwordx4 v8, s[40:43], s60 offen offset:0 lds
    buffer_load_dwordx4 v9, s[40:43], s60 offen offset:1024 lds
    buffer_load_dwordx4 v10, s[40:43], s60 offen offset:2048 lds
    buffer_load_dwordx4 v11, s[40:43], s60 offen offset:3072 lds
    s_add_u32 s81, s81, 245760
    s_add_u32 s78, s78, 1
    s_cmp_le_u32 s78, 7
    s_cbranch_scc1 L_A_lloop
    s_waitcnt vmcnt(12)
    s_barrier
    s_lshl_b32 s79, s77, 1
    s_add_u32 s79, s79, s76
    s_and_b32 s79, s79, 7
    s_mov_b32 s66, 0x76543210
    s_mov_b32 s67, 0xba98
    s_cmp_eq_u32 s79, 0
    s_cselect_b32 s66, 0x76543102, s66
    s_cselect_b32 s67, 0xb98a, s67
    s_cmp_eq_u32 s79, 1
    s_cselect_b32 s66, 0x76542130, s66
    s_cselect_b32 s67, 0xa9b8, s67
    s_cmp_eq_u32 s79, 2
    s_cselect_b32 s66, 0x76532410, s66
    s_cselect_b32 s67, 0xba98, s67
    s_cmp_eq_u32 s79, 3
    s_cselect_b32 s66, 0x76435210, s66
    s_cselect_b32 s67, 0xba98, s67
    s_cmp_eq_u32 s79, 4
    s_cselect_b32 s66, 0x75463210, s66
    s_cselect_b32 s67, 0xba98, s67
    s_cmp_eq_u32 s79, 5
    s_cselect_b32 s66, 0x65743210, s66
    s_cselect_b32 s67, 0xba98, s67
    s_cmp_eq_u32 s79, 6
    s_cselect_b32 s66, 0x68543210, s66
    s_cselect_b32 s67, 0xba97, s67
    s_cmp_eq_u32 s79, 7
    s_cselect_b32 s66, 0x96543210, s66
    s_cselect_b32 s67, 0xba87, s67
    v_lshrrev_b32 v240, 3, v1
    v_lshrrev_b32 v241, 4, v1
    v_lshlrev_b32 v241, 1, v241
    v_and_b32 v242, 7, v1
    v_xor_b32 v241, v241, v242
    v_lshlrev_b32 v241, 4, v241
    v_lshl_add_u32 v240, v240, 12, v241
    v_add_u32 v241, 31744, v240
    v_add_u32 v242, 63488, v240
    v_add_u32 v243, 95232, v240
    s_sub_u32 s60, s29, 5
    s_lshl_b32 s81, s60, 13
    s_lshl_b32 s80, s60, 18
    s_lshl_b32 s60, s76, 7
    s_add_u32 s80, s80, s60
    v_mul_u32_u24 v16, 625, v0
    v_lshrrev_b32 v16, 16, v16
    v_mul_u32_u24 v17, 105, v16
    v_sub_u32 v17, v0, v17
    v_mul_u32_u24 v19, 205, v17
    v_lshrrev_b32 v19, 12, v19
    v_mul_u32_u24 v18, 20, v19
    v_cmp_lt_u32 vcc, 99, v17
    v_sub_u32 v18, v17, v18
    s_nop 0
    v_cndmask_b32 v19, v19, v18, vcc
    v_mad_u32_u24 v19, v16, 5, v19
    v_mad_u32_u24 v20, v16, 20, v18
    v_lshrrev_b32 v21, 2, v19
    v_and_b32 v22, 3, v19
    v_lshrrev_b32 v23, 4, v20
    v_and_b32 v20, 15, v20
    v_lshl_add_u32 v20, v22, 4, v20
    v_lshl_add_u32 v2, v21, 1, v23
    v_lshlrev_b32 v2, 6, v2
    v_add_u32 v2, v2, v20
    v_lshlrev_b32 v2, 4, v2
    v_lshlrev_b32 v3, 4, v19
    v_add_u32 v3, 13312, v3
    v_cmp_lt_u32 vcc, 99, v17
    v_lshrrev_b32 v24, 1, v21
    v_and_b32 v21, 1, v21
    v_cndmask_b32 v2, v2, v3, vcc
    v_lshl_add_u32 v3, v23, 1, v24
    v_add_u32 v24, 11, v24
    v_lshl_add_u32 v22, v22, 4, v16
    v_cndmask_b32 v3, v3, v24, vcc
    v_cndmask_b32 v20, v20, v22, vcc
    v_lshl_add_u32 v3, v3, 6, v20
    v_lshlrev_b32 v3, 4, v3
    v_lshl_add_u32 v3, v21, 3, v3
    v_add_u32 v3, 147456, v3
    v_mov_b32 v25, 2
    v_cndmask_b32 v25, 1, v25, vcc
    v_mov_b32 v16, 420
    v_cmp_gt_u32 vcc, v16, v0
    v_lshlrev_b32 v14, 4, v0
    s_nop 0
    v_cndmask_b32 v15, 0, v25, vcc
    v_cndmask_b32 v2, 0, v2, vcc
    v_add_u32 v2, 106496, v2
    s_mul_i32 s60, s77, 128
    s_add_u32 s60, s60, 69632
    v_mov_b32 v26, s60
    v_and_b32 v27, 3, v1
    s_lshl_b32 s60, s70, 2
    v_add_u32 v27, s60, v27
    v_mul_u32_u24 v27, 128, v27
    v_add_u32 v27, 4096, v27
    v_cmp_gt_u32 vcc, 32, v1
    s_nop 1
    v_cndmask_b32 v26, v27, v26, vcc
    s_waitcnt vmcnt(0)
    s_barrier
    buffer_load_dword v28, v26, s[32:35], 0 offen sc1
    s_cmp_lg_u32 s29, 7
    s_cbranch_scc1 Lnct_1
    s_getpc_b64 s[60:61]
Lpc_2:
    v_lshlrev_b32 v24, 7, v1
    s_add_u32 s62, s60, L_A_tail-Lpc_2+0
    s_addc_u32 s63, s61, -1
    v_min_u32 v25, L_exit-L_A_tail-0, v24
    global_load_dword v253, v25, s[62:63]
    s_add_u32 s62, s60, L_A_post-Lpc_2+0
    s_addc_u32 s63, s61, 0
    v_min_u32 v25, L_exit-L_A_post-0, v24
    global_load_dword v253, v25, s[62:63]
    s_add_u32 s62, s60, L_F_comp-Lpc_2+0
    s_addc_u32 s63, s61, 0
    v_min_u32 v25, L_exit-L_F_comp-0, v24
    global_load_dword v253, v25, s[62:63]
    s_add_u32 s62, s60, L_F_comp-Lpc_2+8192
    s_addc_u32 s63, s61, 0
    v_min_u32 v25, L_exit-L_F_comp-8192, v24
    global_load_dword v253, v25, s[62:63]
Lnct_1:
L_A_post:
    s_sub_u32 s60, s29, 5
    s_cmp_lt_u32 s60, 2
    s_cbranch_scc0 Ln56_3
    s_bfe_u32 s60, s66, 0x4000c
    s_lshl_b32 s60, s60, 19
    s_add_u32 s60, s60, s80
    s_add_u32 m0, s81, 49152
    s_add_u32 s60, s60, 0
    buffer_load_dwordx4 v240, s[48:51], s60 offen offset:0 lds
    buffer_load_dwordx4 v241, s[48:51], s60 offen offset:1024 lds
    buffer_load_dwordx4 v242, s[48:51], s60 offen offset:2048 lds
    buffer_load_dwordx4 v243, s[48:51], s60 offen offset:3072 lds
    s_add_u32 m0, s81, 53248
    s_add_u32 s60, s60, 131072
    buffer_load_dwordx4 v240, s[48:51], s60 offen offset:0 lds
    buffer_load_dwordx4 v241, s[48:51], s60 offen offset:1024 lds
    buffer_load_dwordx4 v242, s[48:51], s60 offen offset:2048 lds
    buffer_load_dwordx4 v243, s[48:51], s60 offen offset:3072 lds
    s_bfe_u32 s60, s66, 0x40010
    s_lshl_b32 s60, s60, 19
    s_add_u32 s60, s60, s80
    s_add_u32 m0, s81, 65536
    s_add_u32 s60, s60, 0
    buffer_load_dwordx4 v240, s[48:51], s60 offen offset:0 lds
    buffer_load_dwordx4 v241, s[48:51], s60 offen offset:1024 lds
    buffer_load_dwordx4 v242, s[48:51], s60 offen offset:2048 lds
    buffer_load_dwordx4 v243, s[48:51], s60 offen offset:3072 lds
    s_add_u32 m0, s81, 69632
    s_add_u32 s60, s60, 131072
    buffer_load_dwordx4 v240, s[48:51], s60 offen offset:0 lds
    buffer_load_dwordx4 v241, s[48:51], s60 offen offset:1024 lds
    buffer_load_dwordx4 v242, s[48:51], s60 offen offset:2048 lds
    buffer_load_dwordx4 v243, s[48:51], s60 offen offset:3072 lds
    s_bfe_u32 s60, s66, 0x40014
    s_lshl_b32 s60, s60, 19
    s_add_u32 s60, s60, s80
    s_add_u32 m0, s81, 81920
    s_add_u32 s60, s60, 0
    buffer_load_dwordx4 v240, s[48:51], s60 offen offset:0 lds
    buffer_load_dwordx4 v241, s[48:51], s60 offen offset:1024 lds
    buffer_load_dwordx4 v242, s[48:51], s60 offen offset:2048 lds
    buffer_load_dwordx4 v243, s[48:51], s60 offen offset:3072 lds
    s_add_u32 m0, s81, 86016
    s_add_u32 s60, s60, 131072
    buffer_load_dwordx4 v240, s[48:51], s60 offen offset:0 lds
    buffer_load_dwordx4 v241, s[48:51], s60 offen offset:1024 lds
    buffer_load_dwordx4 v242, s[48:51], s60 offen offset:2048 lds
    buffer_load_dwordx4 v243, s[48:51], s60 offen offset:3072 lds
Ln56_3:
    s_barrier
    s_sub_u32 s60, s29, 5
    s_cmp_lt_u32 s60, 2
    s_cbranch_scc0 Ln56_4
    s_bfe_u32 s60, s66, 0x40000
    s_lshl_b32 s60, s60, 19
    s_add_u32 s60, s60, s80
    s_add_u32 m0, s81, 0
    s_add_u32 s60, s60, 0
    buffer_load_dwordx4 v240, s[48:51], s60 offen offset:0 lds
    buffer_load_dwordx4 v241, s[48:51], s60 offen offset:1024 lds
    buffer_load_dwordx4 v242, s[48:51], s60 offen offset:2048 lds
    buffer_load_dwordx4 v243, s[48:51], s60 offen offset:3072 lds
    s_add_u32 m0, s81, 4096
    s_add_u32 s60, s60, 131072
    buffer_load_dwordx4 v240, s[48:51], s60 offen offset:0 lds
    buffer_load_dwordx4 v241, s[48:51], s60 offen offset:1024 lds
    buffer_load_dwordx4 v242, s[48:51], s60 offen offset:2048 lds
    buffer_load_dwordx4 v243, s[48:51], s60 offen offset:3072 lds
    s_bfe_u32 s60, s66, 0x40004
    s_lshl_b32 s60, s60, 19
    s_add_u32 s60, s60, s80
    s_add_u32 m0, s81, 16384
    s_add_u32 s60, s60, 0
    buffer_load_dwordx4 v240, s[48:51], s60 offen offset:0 lds
    buffer_load_dwordx4 v241, s[48:51], s60 offen offset:1024 lds
    buffer_load_dwordx4 v242, s[48:51], s60 offen offset:2048 lds
    buffer_load_dwordx4 v243, s[48:51], s60 offen offset:3072 lds
    s_add_u32 m0, s81, 20480
    s_add_u32 s60, s60, 131072
    buffer_load_dwordx4 v240, s[48:51], s60 offen offset:0 lds
    buffer_load_dwordx4 v241, s[48:51], s60 offen offset:1024 lds
    buffer_load_dwordx4 v242, s[48:51], s60 offen offset:2048 lds
    buffer_load_dwordx4 v243, s[48:51], s60 offen offset:3072 lds
    s_bfe_u32 s60, s66, 0x40008
    s_lshl_b32 s60, s60, 19
    s_add_u32 s60, s60, s80
    s_add_u32 m0, s81, 32768
    s_add_u32 s60, s60, 0
    buffer_load_dwordx4 v240, s[48:51], s60 offen offset:0 lds
    buffer_load_dwordx4 v241, s[48:51], s60 offen offset:1024 lds
    buffer_load_dwordx4 v242, s[48:51], s60 offen offset:2048 lds
    buffer_load_dwordx4 v243, s[48:51], s60 offen offset:3072 lds
    s_add_u32 m0, s81, 36864
    s_add_u32 s60, s60, 131072
    buffer_load_dwordx4 v240, s[48:51], s60 offen offset:0 lds
    buffer_load_dwordx4 v241, s[48:51], s60 offen offset:1024 lds
    buffer_load_dwordx4 v242, s[48:51], s60 offen offset:2048 lds
    buffer_load_dwordx4 v243, s[48:51], s60 offen offset:3072 lds
Ln56_4:
    s_cmp_eq_u32 s29, 7
    s_cbranch_scc1 L_A_poller
    s_barrier
    ds_read_b128 v[64:67], v2 offset:0
    ds_read_b128 v[68:71], v2 offset:14336
    ds_read_b128 v[72:75], v2 offset:28672
    ds_read_b128 v[76:79], v2 offset:43008
    s_lshl_b32 s60, s71, 4
    s_add_u32 s60, s60, s70
    s_mul_i32 s60, s60, 7168
    s_add_u32 s60, s60, 131072
    v_cmp_ne_u32 vcc, 0, v15
    s_waitcnt lgkmcnt(0)
    v_pk_add_f32 v[64:65], v[64:65], v[68:69]
    v_pk_add_f32 v[66:67], v[66:67], v[70:71]
    v_pk_add_f32 v[72:73], v[72:73], v[76:77]
    v_pk_add_f32 v[74:75], v[74:75], v[78:79]
    v_pk_add_f32 v[64:65], v[64:65], v[72:73]
    v_pk_add_f32 v[66:67], v[66:67], v[74:75]
    v_mov_b32_sdwa v64, s28 dst_sel:BYTE_0 dst_unused:UNUSED_PRESERVE src0_sel:BYTE_0
    v_mov_b32_sdwa v65, s28 dst_sel:BYTE_0 dst_unused:UNUSED_PRESERVE src0_sel:BYTE_1
    v_mov_b32_sdwa v66, s28 dst_sel:BYTE_0 dst_unused:UNUSED_PRESERVE src0_sel:BYTE_2
    v_mov_b32_sdwa v67, s28 dst_sel:BYTE_0 dst_unused:UNUSED_PRESERVE src0_sel:BYTE_3
    s_mov_b64 exec, vcc
    buffer_store_dwordx4 v[64:67], v14, s[32:35], s60 offen sc1
    s_mov_b64 exec, -1
    s_barrier
    v_lshlrev_b32 v16, 4, v1
    s_lshl_b32 s60, s83, 12
    s_add_u32 s60, s60, 147456
    v_add_u32 v16, s60, v16
    v_mov_b32 v20, 0
    v_mov_b32 v21, 0
    v_mov_b32 v22, 0
    v_mov_b32 v23, 0
    ds_write_b128 v16, v[20:23] offset:0
    ds_write_b128 v16, v[20:23] offset:1024
    ds_write_b128 v16, v[20:23] offset:2048
    ds_write_b128 v16, v[20:23] offset:3072
    s_waitcnt lgkmcnt(0)
    s_sub_u32 s60, s29, 5
    s_cmp_lt_u32 s60, 2
    s_cbranch_scc0 Ln56_5
    s_bfe_u32 s60, s66, 0x40018
    s_lshl_b32 s60, s60, 19
    s_add_u32 s60, s60, s80
    s_add_u32 m0, s81, 98304
    s_add_u32 s60, s60, 0
    buffer_load_dwordx4 v240, s[48:51], s60 offen offset:0 lds
    buffer_load_dwordx4 v241, s[48:51], s60 offen offset:1024 lds
    buffer_load_dwordx4 v242, s[48:51], s60 offen offset:2048 lds
    buffer_load_dwordx4 v243, s[48:51], s60 offen offset:3072 lds
    s_add_u32 m0, s81, 102400
    s_add_u32 s60, s60, 131072
    buffer_load_dwordx4 v240, s[48:51], s60 offen offset:0 lds
    buffer_load_dwordx4 v241, s[48:51], s60 offen offset:1024 lds
    buffer_load_dwordx4 v242, s[48:51], s60 offen offset:2048 lds
    buffer_load_dwordx4 v243, s[48:51], s60 offen offset:3072 lds
    s_bfe_u32 s60, s66, 0x4001c
    s_lshl_b32 s60, s60, 19
    s_add_u32 s60, s60, s80
    s_add_u32 m0, s81, 114688
    s_add_u32 s60, s60, 0
    buffer_load_dwordx4 v240, s[48:51], s60 offen offset:0 lds
    buffer_load_dwordx4 v241, s[48:51], s60 offen offset:1024 lds
    buffer_load_dwordx4 v242, s[48:51], s60 offen offset:2048 lds
    buffer_load_dwordx4 v243, s[48:51], s60 offen offset:3072 lds
    s_add_u32 m0, s81, 118784
    s_add_u32 s60, s60, 131072
    buffer_load_dwordx4 v240, s[48:51], s60 offen offset:0 lds
    buffer_load_dwordx4 v241, s[48:51], s60 offen offset:1024 lds
    buffer_load_dwordx4 v242, s[48:51], s60 offen offset:2048 lds
    buffer_load_dwordx4 v243, s[48:51], s60 offen offset:3072 lds
    s_mov_b32 s66, s67
    s_barrier
    s_call_b64 s[68:69], L_gather
    s_waitcnt lgkmcnt(0)
    s_barrier
    s_branch L_F_loader
Ln56_5:
    s_barrier
    s_call_b64 s[68:69], L_gather
    s_waitcnt lgkmcnt(0)
    s_barrier
    s_branch L_F_u4
L_A_poller:
    s_waitcnt vmcnt(4)
    v_cmp_ne_u32 vcc, s28, v28
    s_nop 1
    s_cmp_eq_u64 vcc, 0
    s_cbranch_scc1 L_A_pok
    s_mov_b32 s78, 0
Lpoll_6:
    buffer_load_dword v18, v26, s[32:35], 0 offen sc1
    s_waitcnt vmcnt(0)
    v_cmp_ne_u32 vcc, s28, v18
    s_nop 1
    s_cmp_eq_u64 vcc, 0
    s_cbranch_scc1 Lpdone_7
    s_add_u32 s78, s78, 1
    s_cmp_lt_u32 s78, 131072
    s_cbranch_scc0 Lpdone_7
    s_sleep 1
    s_branch Lpoll_6
Lpdone_7:
L_A_pok:
    s_barrier
    s_barrier
    v_lshlrev_b32 v16, 4, v1
    s_lshl_b32 s60, s83, 12
    s_add_u32 s60, s60, 147456
    v_add_u32 v16, s60, v16
    v_mov_b32 v20, 0
    v_mov_b32 v21, 0
    v_mov_b32 v22, 0
    v_mov_b32 v23, 0
    ds_write_b128 v16, v[20:23] offset:0
    ds_write_b128 v16, v[20:23] offset:1024
    ds_write_b128 v16, v[20:23] offset:2048
    ds_write_b128 v16, v[20:23] offset:3072
    s_waitcnt lgkmcnt(0)
    s_barrier
    s_barrier
    s_branch L_F_poller
L_gather:
    s_mul_i32 s61, s71, 114688
    s_add_u32 s61, s61, 131072
    v_cmp_ne_u32 s[64:65], 0, v15
    s_mov_b32 s78, 0
    s_lshl_b32 s62, s70, 1
    s_mov_b64 exec, s[64:65]
    s_add_u32 s60, s62, 0
    s_and_b32 s60, s60, 15
    s_mul_i32 s60, s60, 7168
    s_add_u32 s60, s60, s61
    buffer_load_dwordx4 v[64:67], v14, s[32:35], s60 offen sc1
    s_add_u32 s60, s60, 7168
    buffer_load_dwordx4 v[68:71], v14, s[32:35], s60 offen sc1
    s_add_u32 s60, s62, 2
    s_and_b32 s60, s60, 15
    s_mul_i32 s60, s60, 7168
    s_add_u32 s60, s60, s61
    buffer_load_dwordx4 v[72:75], v14, s[32:35], s60 offen sc1
    s_add_u32 s60, s60, 7168
    buffer_load_dwordx4 v[76:79], v14, s[32:35], s60 offen sc1
    s_add_u32 s60, s62, 4
    s_and_b32 s60, s60, 15
    s_mul_i32 s60, s60, 7168
    s_add_u32 s60, s60, s61
    buffer_load_dwordx4 v[80:83], v14, s[32:35], s60 offen sc1
    s_add_u32 s60, s60, 7168
    buffer_load_dwordx4 v[84:87], v14, s[32:35], s60 offen sc1
    s_add_u32 s60, s62, 6
    s_and_b32 s60, s60, 15
    s_mul_i32 s60, s60, 7168
    s_add_u32 s60, s60, s61
    buffer_load_dwordx4 v[88:91], v14, s[32:35], s60 offen sc1
    s_add_u32 s60, s60, 7168
    buffer_load_dwordx4 v[92:95], v14, s[32:35], s60 offen sc1
    s_add_u32 s60, s62, 8
    s_and_b32 s60, s60, 15
    s_mul_i32 s60, s60, 7168
    s_add_u32 s60, s60, s61
    buffer_load_dwordx4 v[96:99], v14, s[32:35], s60 offen sc1
    s_add_u32 s60, s60, 7168
    buffer_load_dwordx4 v[100:103], v14, s[32:35], s60 offen sc1
    s_add_u32 s60, s62, 10
    s_and_b32 s60, s60, 15
    s_mul_i32 s60, s60, 7168
    s_add_u32 s60, s60, s61
    buffer_load_dwordx4 v[104:107], v14, s[32:35], s60 offen sc1
    s_add_u32 s60, s60, 7168
    buffer_load_dwordx4 v[108:111], v14, s[32:35], s60 offen sc1
    s_add_u32 s60, s62, 12
    s_and_b32 s60, s60, 15
    s_mul_i32 s60, s60, 7168
    s_add_u32 s60, s60, s61
    buffer_load_dwordx4 v[112:115], v14, s[32:35], s60 offen sc1
    s_add_u32 s60, s60, 7168
    buffer_load_dwordx4 v[116:119], v14, s[32:35], s60 offen sc1
    s_add_u32 s60, s62, 14
    s_and_b32 s60, s60, 15
    s_mul_i32 s60, s60, 7168
    s_add_u32 s60, s60, s61
    buffer_load_dwordx4 v[120:123], v14, s[32:35], s60 offen sc1
    s_add_u32 s60, s60, 7168
    buffer_load_dwordx4 v[124:127], v14, s[32:35], s60 offen sc1
    s_waitcnt vmcnt(14)
L_gchk0:
    v_cmpx_eq_u32_sdwa vcc, v64, s28 src0_sel:BYTE_0 src1_sel:BYTE_0
    v_cmpx_eq_u32_sdwa vcc, v65, s28 src0_sel:BYTE_0 src1_sel:BYTE_1
    v_cmpx_eq_u32_sdwa vcc, v66, s28 src0_sel:BYTE_0 src1_sel:BYTE_2
    v_cmpx_eq_u32_sdwa vcc, v67, s28 src0_sel:BYTE_0 src1_sel:BYTE_3
    v_cmpx_eq_u32_sdwa vcc, v68, s28 src0_sel:BYTE_0 src1_sel:BYTE_0
    v_cmpx_eq_u32_sdwa vcc, v69, s28 src0_sel:BYTE_0 src1_sel:BYTE_1
    v_cmpx_eq_u32_sdwa vcc, v70, s28 src0_sel:BYTE_0 src1_sel:BYTE_2
    v_cmpx_eq_u32_sdwa vcc, v71, s28 src0_sel:BYTE_0 src1_sel:BYTE_3
    s_add_u32 s78, s78, 1
    s_cmp_eq_u64 exec, s[64:65]
    s_mov_b64 exec, s[64:65]
    s_cbranch_scc1 L_gok0
    s_cmp_ge_u32 s78, 131072
    s_cbranch_scc1 L_gok0
    s_add_u32 s60, s62, 0
    s_and_b32 s60, s60, 15
    s_mul_i32 s60, s60, 7168
    s_add_u32 s60, s60, s61
    buffer_load_dwordx4 v[64:67], v14, s[32:35], s60 offen sc1
    s_add_u32 s60, s60, 7168
    buffer_load_dwordx4 v[68:71], v14, s[32:35], s60 offen sc1
    s_waitcnt vmcnt(0)
    s_branch L_gchk0
L_gok0:
    v_and_b32 v64, 0xffffff00, v64
    v_and_b32 v65, 0xffffff00, v65
    v_and_b32 v66, 0xffffff00, v66
    v_and_b32 v67, 0xffffff00, v67
    v_and_b32 v68, 0xffffff00, v68
    v_and_b32 v69, 0xffffff00, v69
    v_and_b32 v70, 0xffffff00, v70
    v_and_b32 v71, 0xffffff00, v71
    v_pk_add_f32 v[64:65], v[64:65], v[68:69]
    v_pk_add_f32 v[66:67], v[66:67], v[70:71]
    s_waitcnt vmcnt(12)
L_gchk2:
    v_cmpx_eq_u32_sdwa vcc, v72, s28 src0_sel:BYTE_0 src1_sel:BYTE_0
    v_cmpx_eq_u32_sdwa vcc, v73, s28 src0_sel:BYTE_0 src1_sel:BYTE_1
    v_cmpx_eq_u32_sdwa vcc, v74, s28 src0_sel:BYTE_0 src1_sel:BYTE_2
    v_cmpx_eq_u32_sdwa vcc, v75, s28 src0_sel:BYTE_0 src1_sel:BYTE_3
    v_cmpx_eq_u32_sdwa vcc, v76, s28 src0_sel:BYTE_0 src1_sel:BYTE_0
    v_cmpx_eq_u32_sdwa vcc, v77, s28 src0_sel:BYTE_0 src1_sel:BYTE_1
    v_cmpx_eq_u32_sdwa vcc, v78, s28 src0_sel:BYTE_0 src1_sel:BYTE_2
    v_cmpx_eq_u32_sdwa vcc, v79, s28 src0_sel:BYTE_0 src1_sel:BYTE_3
    s_add_u32 s78, s78, 1
    s_cmp_eq_u64 exec, s[64:65]
    s_mov_b64 exec, s[64:65]
    s_cbranch_scc1 L_gok2
    s_cmp_ge_u32 s78, 131072
    s_cbranch_scc1 L_gok2
    s_add_u32 s60, s62, 2
    s_and_b32 s60, s60, 15
    s_mul_i32 s60, s60, 7168
    s_add_u32 s60, s60, s61
    buffer_load_dwordx4 v[72:75], v14, s[32:35], s60 offen sc1
    s_add_u32 s60, s60, 7168
    buffer_load_dwordx4 v[76:79], v14, s[32:35], s60 offen sc1
    s_waitcnt vmcnt(0)
    s_branch L_gchk2
L_gok2:
    v_and_b32 v72, 0xffffff00, v72
    v_and_b32 v73, 0xffffff00, v73
    v_and_b32 v74, 0xffffff00, v74
    v_and_b32 v75, 0xffffff00, v75
    v_and_b32 v76, 0xffffff00, v76
    v_and_b32 v77, 0xffffff00, v77
    v_and_b32 v78, 0xffffff00, v78
    v_and_b32 v79, 0xffffff00, v79
    v_pk_add_f32 v[72:73], v[72:73], v[76:77]
    v_pk_add_f32 v[74:75], v[74:75], v[78:79]
    v_pk_add_f32 v[64:65], v[64:65], v[72:73]
    v_pk_add_f32 v[66:67], v[66:67], v[74:75]
    s_waitcnt vmcnt(10)
L_gchk4:
    v_cmpx_eq_u32_sdwa vcc, v80, s28 src0_sel:BYTE_0 src1_sel:BYTE_0
    v_cmpx_eq_u32_sdwa vcc, v81, s28 src0_sel:BYTE_0 src1_sel:BYTE_1
    v_cmpx_eq_u32_sdwa vcc, v82, s28 src0_sel:BYTE_0 src1_sel:BYTE_2
    v_cmpx_eq_u32_sdwa vcc, v83, s28 src0_sel:BYTE_0 src1_sel:BYTE_3
    v_cmpx_eq_u32_sdwa vcc, v84, s28 src0_sel:BYTE_0 src1_sel:BYTE_0
    v_cmpx_eq_u32_sdwa vcc, v85, s28 src0_sel:BYTE_0 src1_sel:BYTE_1
    v_cmpx_eq_u32_sdwa vcc, v86, s28 src0_sel:BYTE_0 src1_sel:BYTE_2
    v_cmpx_eq_u32_sdwa vcc, v87, s28 src0_sel:BYTE_0 src1_sel:BYTE_3
    s_add_u32 s78, s78, 1
    s_cmp_eq_u64 exec, s[64:65]
    s_mov_b64 exec, s[64:65]
    s_cbranch_scc1 L_gok4
    s_cmp_ge_u32 s78, 131072
    s_cbranch_scc1 L_gok4
    s_add_u32 s60, s62, 4
    s_and_b32 s60, s60, 15
    s_mul_i32 s60, s60, 7168
    s_add_u32 s60, s60, s61
    buffer_load_dwordx4 v[80:83], v14, s[32:35], s60 offen sc1
    s_add_u32 s60, s60, 7168
    buffer_load_dwordx4 v[84:87], v14, s[32:35], s60 offen sc1
    s_waitcnt vmcnt(0)
    s_branch L_gchk4
L_gok4:
    v_and_b32 v80, 0xffffff00, v80
    v_and_b32 v81, 0xffffff00, v81
    v_and_b32 v82, 0xffffff00, v82
    v_and_b32 v83, 0xffffff00, v83
    v_and_b32 v84, 0xffffff00, v84
    v_and_b32 v85, 0xffffff00, v85
    v_and_b32 v86, 0xffffff00, v86
    v_and_b32 v87, 0xffffff00, v87
    v_pk_add_f32 v[80:81], v[80:81], v[84:85]
    v_pk_add_f32 v[82:83], v[82:83], v[86:87]
    v_pk_add_f32 v[64:65], v[64:65], v[80:81]
    v_pk_add_f32 v[66:67], v[66:67], v[82:83]
    s_waitcnt vmcnt(8)
L_gchk6:
    v_cmpx_eq_u32_sdwa vcc, v88, s28 src0_sel:BYTE_0 src1_sel:BYTE_0
    v_cmpx_eq_u32_sdwa vcc, v89, s28 src0_sel:BYTE_0 src1_sel:BYTE_1
    v_cmpx_eq_u32_sdwa vcc, v90, s28 src0_sel:BYTE_0 src1_sel:BYTE_2
    v_cmpx_eq_u32_sdwa vcc, v91, s28 src0_sel:BYTE_0 src1_sel:BYTE_3
    v_cmpx_eq_u32_sdwa vcc, v92, s28 src0_sel:BYTE_0 src1_sel:BYTE_0
    v_cmpx_eq_u32_sdwa vcc, v93, s28 src0_sel:BYTE_0 src1_sel:BYTE_1
    v_cmpx_eq_u32_sdwa vcc, v94, s28 src0_sel:BYTE_0 src1_sel:BYTE_2
    v_cmpx_eq_u32_sdwa vcc, v95, s28 src0_sel:BYTE_0 src1_sel:BYTE_3
    s_add_u32 s78, s78, 1
    s_cmp_eq_u64 exec, s[64:65]
    s_mov_b64 exec, s[64:65]
    s_cbranch_scc1 L_gok6
    s_cmp_ge_u32 s78, 131072
    s_cbranch_scc1 L_gok6
    s_add_u32 s60, s62, 6
    s_and_b32 s60, s60, 15
    s_mul_i32 s60, s60, 7168
    s_add_u32 s60, s60, s61
    buffer_load_dwordx4 v[88:91], v14, s[32:35], s60 offen sc1
    s_add_u32 s60, s60, 7168
    buffer_load_dwordx4 v[92:95], v14, s[32:35], s60 offen sc1
    s_waitcnt vmcnt(0)
    s_branch L_gchk6
L_gok6:
    v_and_b32 v88, 0xffffff00, v88
    v_and_b32 v89, 0xffffff00, v89
    v_and_b32 v90, 0xffffff00, v90
    v_and_b32 v91, 0xffffff00, v91
    v_and_b32 v92, 0xffffff00, v92
    v_and_b32 v93, 0xffffff00, v93
    v_and_b32 v94, 0xffffff00, v94
    v_and_b32 v95, 0xffffff00, v95
    v_pk_add_f32 v[88:89], v[88:89], v[92:93]
    v_pk_add_f32 v[90:91], v[90:91], v[94:95]
    v_pk_add_f32 v[64:65], v[64:65], v[88:89]
    v_pk_add_f32 v[66:67], v[66:67], v[90:91]
    s_waitcnt vmcnt(6)
L_gchk8:
    v_cmpx_eq_u32_sdwa vcc, v96, s28 src0_sel:BYTE_0 src1_sel:BYTE_0
    v_cmpx_eq_u32_sdwa vcc, v97, s28 src0_sel:BYTE_0 src1_sel:BYTE_1
    v_cmpx_eq_u32_sdwa vcc, v98, s28 src0_sel:BYTE_0 src1_sel:BYTE_2
    v_cmpx_eq_u32_sdwa vcc, v99, s28 src0_sel:BYTE_0 src1_sel:BYTE_3
    v_cmpx_eq_u32_sdwa vcc, v100, s28 src0_sel:BYTE_0 src1_sel:BYTE_0
    v_cmpx_eq_u32_sdwa vcc, v101, s28 src0_sel:BYTE_0 src1_sel:BYTE_1
    v_cmpx_eq_u32_sdwa vcc, v102, s28 src0_sel:BYTE_0 src1_sel:BYTE_2
    v_cmpx_eq_u32_sdwa vcc, v103, s28 src0_sel:BYTE_0 src1_sel:BYTE_3
    s_add_u32 s78, s78, 1
    s_cmp_eq_u64 exec, s[64:65]
    s_mov_b64 exec, s[64:65]
    s_cbranch_scc1 L_gok8
    s_cmp_ge_u32 s78, 131072
    s_cbranch_scc1 L_gok8
    s_add_u32 s60, s62, 8
    s_and_b32 s60, s60, 15
    s_mul_i32 s60, s60, 7168
    s_add_u32 s60, s60, s61
    buffer_load_dwordx4 v[96:99], v14, s[32:35], s60 offen sc1
    s_add_u32 s60, s60, 7168
    buffer_load_dwordx4 v[100:103], v14, s[32:35], s60 offen sc1
    s_waitcnt vmcnt(0)
    s_branch L_gchk8
L_gok8:
    v_and_b32 v96, 0xffffff00, v96
    v_and_b32 v97, 0xffffff00, v97
    v_and_b32 v98, 0xffffff00, v98
    v_and_b32 v99, 0xffffff00, v99
    v_and_b32 v100, 0xffffff00, v100
    v_and_b32 v101, 0xffffff00, v101
    v_and_b32 v102, 0xffffff00, v102
    v_and_b32 v103, 0xffffff00, v103
    v_pk_add_f32 v[96:97], v[96:97], v[100:101]
    v_pk_add_f32 v[98:99], v[98:99], v[102:103]
    v_pk_add_f32 v[64:65], v[64:65], v[96:97]
    v_pk_add_f32 v[66:67], v[66:67], v[98:99]
    s_waitcnt vmcnt(4)
L_gchk10:
    v_cmpx_eq_u32_sdwa vcc, v104, s28 src0_sel:BYTE_0 src1_sel:BYTE_0
    v_cmpx_eq_u32_sdwa vcc, v105, s28 src0_sel:BYTE_0 src1_sel:BYTE_1
    v_cmpx_eq_u32_sdwa vcc, v106, s28 src0_sel:BYTE_0 src1_sel:BYTE_2
    v_cmpx_eq_u32_sdwa vcc, v107, s28 src0_sel:BYTE_0 src1_sel:BYTE_3
    v_cmpx_eq_u32_sdwa vcc, v108, s28 src0_sel:BYTE_0 src1_sel:BYTE_0
    v_cmpx_eq_u32_sdwa vcc, v109, s28 src0_sel:BYTE_0 src1_sel:BYTE_1
    v_cmpx_eq_u32_sdwa vcc, v110, s28 src0_sel:BYTE_0 src1_sel:BYTE_2
    v_cmpx_eq_u32_sdwa vcc, v111, s28 src0_sel:BYTE_0 src1_sel:BYTE_3
    s_add_u32 s78, s78, 1
    s_cmp_eq_u64 exec, s[64:65]
    s_mov_b64 exec, s[64:65]
    s_cbranch_scc1 L_gok10
    s_cmp_ge_u32 s78, 131072
    s_cbranch_scc1 L_gok10
    s_add_u32 s60, s62, 10
    s_and_b32 s60, s60, 15
    s_mul_i32 s60, s60, 7168
    s_add_u32 s60, s60, s61
    buffer_load_dwordx4 v[104:107], v14, s[32:35], s60 offen sc1
    s_add_u32 s60, s60, 7168
    buffer_load_dwordx4 v[108:111], v14, s[32:35], s60 offen sc1
    s_waitcnt vmcnt(0)
    s_branch L_gchk10
L_gok10:
    v_and_b32 v104, 0xffffff00, v104
    v_and_b32 v105, 0xffffff00, v105
    v_and_b32 v106, 0xffffff00, v106
    v_and_b32 v107, 0xffffff00, v107
    v_and_b32 v108, 0xffffff00, v108
    v_and_b32 v109, 0xffffff00, v109
    v_and_b32 v110, 0xffffff00, v110
    v_and_b32 v111, 0xffffff00, v111
    v_pk_add_f32 v[104:105], v[104:105], v[108:109]
    v_pk_add_f32 v[106:107], v[106:107], v[110:111]
    v_pk_add_f32 v[64:65], v[64:65], v[104:105]
    v_pk_add_f32 v[66:67], v[66:67], v[106:107]
    s_waitcnt vmcnt(2)
L_gchk12:
    v_cmpx_eq_u32_sdwa vcc, v112, s28 src0_sel:BYTE_0 src1_sel:BYTE_0
    v_cmpx_eq_u32_sdwa vcc, v113, s28 src0_sel:BYTE_0 src1_sel:BYTE_1
    v_cmpx_eq_u32_sdwa vcc, v114, s28 src0_sel:BYTE_0 src1_sel:BYTE_2
    v_cmpx_eq_u32_sdwa vcc, v115, s28 src0_sel:BYTE_0 src1_sel:BYTE_3
    v_cmpx_eq_u32_sdwa vcc, v116, s28 src0_sel:BYTE_0 src1_sel:BYTE_0
    v_cmpx_eq_u32_sdwa vcc, v117, s28 src0_sel:BYTE_0 src1_sel:BYTE_1
    v_cmpx_eq_u32_sdwa vcc, v118, s28 src0_sel:BYTE_0 src1_sel:BYTE_2
    v_cmpx_eq_u32_sdwa vcc, v119, s28 src0_sel:BYTE_0 src1_sel:BYTE_3
    s_add_u32 s78, s78, 1
    s_cmp_eq_u64 exec, s[64:65]
    s_mov_b64 exec, s[64:65]
    s_cbranch_scc1 L_gok12
    s_cmp_ge_u32 s78, 131072
    s_cbranch_scc1 L_gok12
    s_add_u32 s60, s62, 12
    s_and_b32 s60, s60, 15
    s_mul_i32 s60, s60, 7168
    s_add_u32 s60, s60, s61
    buffer_load_dwordx4 v[112:115], v14, s[32:35], s60 offen sc1
    s_add_u32 s60, s60, 7168
    buffer_load_dwordx4 v[116:119], v14, s[32:35], s60 offen sc1
    s_waitcnt vmcnt(0)
    s_branch L_gchk12
L_gok12:
    v_and_b32 v112, 0xffffff00, v112
    v_and_b32 v113, 0xffffff00, v113
    v_and_b32 v114, 0xffffff00, v114
    v_and_b32 v115, 0xffffff00, v115
    v_and_b32 v116, 0xffffff00, v116
    v_and_b32 v117, 0xffffff00, v117
    v_and_b32 v118, 0xffffff00, v118
    v_and_b32 v119, 0xffffff00, v119
    v_pk_add_f32 v[112:113], v[112:113], v[116:117]
    v_pk_add_f32 v[114:115], v[114:115], v[118:119]
    v_pk_add_f32 v[64:65], v[64:65], v[112:113]
    v_pk_add_f32 v[66:67], v[66:67], v[114:115]
    s_waitcnt vmcnt(0)
L_gchk14:
    v_cmpx_eq_u32_sdwa vcc, v120, s28 src0_sel:BYTE_0 src1_sel:BYTE_0
    v_cmpx_eq_u32_sdwa vcc, v121, s28 src0_sel:BYTE_0 src1_sel:BYTE_1
    v_cmpx_eq_u32_sdwa vcc, v122, s28 src0_sel:BYTE_0 src1_sel:BYTE_2
    v_cmpx_eq_u32_sdwa vcc, v123, s28 src0_sel:BYTE_0 src1_sel:BYTE_3
    v_cmpx_eq_u32_sdwa vcc, v124, s28 src0_sel:BYTE_0 src1_sel:BYTE_0
    v_cmpx_eq_u32_sdwa vcc, v125, s28 src0_sel:BYTE_0 src1_sel:BYTE_1
    v_cmpx_eq_u32_sdwa vcc, v126, s28 src0_sel:BYTE_0 src1_sel:BYTE_2
    v_cmpx_eq_u32_sdwa vcc, v127, s28 src0_sel:BYTE_0 src1_sel:BYTE_3
    s_add_u32 s78, s78, 1
    s_cmp_eq_u64 exec, s[64:65]
    s_mov_b64 exec, s[64:65]
    s_cbranch_scc1 L_gok14
    s_cmp_ge_u32 s78, 131072
    s_cbranch_scc1 L_gok14
    s_add_u32 s60, s62, 14
    s_and_b32 s60, s60, 15
    s_mul_i32 s60, s60, 7168
    s_add_u32 s60, s60, s61
    buffer_load_dwordx4 v[120:123], v14, s[32:35], s60 offen sc1
    s_add_u32 s60, s60, 7168
    buffer_load_dwordx4 v[124:127], v14, s[32:35], s60 offen sc1
    s_waitcnt vmcnt(0)
    s_branch L_gchk14
L_gok14:
    v_and_b32 v120, 0xffffff00, v120
    v_and_b32 v121, 0xffffff00, v121
    v_and_b32 v122, 0xffffff00, v122
    v_and_b32 v123, 0xffffff00, v123
    v_and_b32 v124, 0xffffff00, v124
    v_and_b32 v125, 0xffffff00, v125
    v_and_b32 v126, 0xffffff00, v126
    v_and_b32 v127, 0xffffff00, v127
    v_pk_add_f32 v[120:121], v[120:121], v[124:125]
    v_pk_add_f32 v[122:123], v[122:123], v[126:127]
    v_pk_add_f32 v[64:65], v[64:65], v[120:121]
    v_pk_add_f32 v[66:67], v[66:67], v[122:123]
    s_mov_b64 exec, -1
    v_cvt_pk_bf16_f32 v64, v64, v65
    v_cvt_pk_bf16_f32 v65, v66, v67
    v_cmp_ne_u32 vcc, 0, v15
    v_cmp_eq_u32 s[60:61], 2, v15
    s_nop 1
    s_mov_b64 exec, vcc
    ds_write_b64 v3, v[64:65]
    s_mov_b64 exec, s[60:61]
    ds_write_b64 v3, v[64:65] offset:64
    ds_write_b64 v3, v[64:65] offset:128
    ds_write_b64 v3, v[64:65] offset:192
    s_mov_b64 exec, -1
    s_setpc_b64 s[68:69]
L_roleB:
    s_mov_b32 s95, 0
    s_cmp_ge_u32 s31, 16
    s_cbranch_scc1 L_B_pfrole
    s_lshl_b32 s74, s30, 4
    s_add_u32 s74, s74, s31
    s_lshl_b32 s60, s74, 3
    s_add_u32 s60, s60, s29
    s_mul_i32 s60, s60, 5120
    v_lshrrev_b32 v2, 4, v1
    v_and_b32 v3, 15, v1
    v_lshlrev_b32 v3, 4, v3
    v_mul_u32_u24 v4, 1280, v2
    v_add_u32 v4, v4, v3
    buffer_load_dwordx4 v[16:19], v4, s[36:39], s60 offen offset:0
    buffer_load_dwordx4 v[20:23], v4, s[36:39], s60 offen offset:256
    buffer_load_dwordx4 v[24:27], v4, s[36:39], s60 offen offset:512
    buffer_load_dwordx4 v[28:31], v4, s[36:39], s60 offen offset:768
    buffer_load_dwordx4 v[32:35], v4, s[36:39], s60 offen offset:1024
    s_mov_b32 s52, s20
    s_and_b32 s53, s21, 0xffff
    s_mov_b32 s54, 0x500
    s_mov_b32 s55, 0x20000
    buffer_load_dwordx4 v[64:67], v3, s[52:55], 0 offen offset:0
    buffer_load_dwordx4 v[68:71], v3, s[52:55], 0 offen offset:256
    buffer_load_dwordx4 v[72:75], v3, s[52:55], 0 offen offset:512
    buffer_load_dwordx4 v[76:79], v3, s[52:55], 0 offen offset:768
    buffer_load_dwordx4 v[80:83], v3, s[52:55], 0 offen offset:1024
    s_mov_b32 s40, s12
    s_and_b32 s41, s13, 0xffff
    s_mov_b32 s42, 0x600000
    s_mov_b32 s43, 0x20000
    s_mul_i32 s79, s31, 205
    s_lshr_b32 s79, s79, 10
    s_mul_i32 s72, s79, 5
    s_sub_u32 s72, s31, s72
    s_mul_i32 s73, s30, 6
    s_add_u32 s73, s73, s79
    s_mov_b32 s56, s14
    s_and_b32 s57, s15, 0xffff
    s_mov_b32 s58, 0xc00
    s_mov_b32 s59, 0x20000
    v_lshrrev_b32 v5, 4, v1
    v_lshlrev_b32 v5, 3, v5
    s_lshl_b32 s60, s73, 7
    buffer_load_dwordx2 v[36:37], v5, s[56:59], s60 offen offset:0
    buffer_load_dwordx2 v[38:39], v5, s[56:59], s60 offen offset:32
    buffer_load_dwordx2 v[40:41], v5, s[56:59], s60 offen offset:64
    buffer_load_dwordx2 v[42:43], v5, s[56:59], s60 offen offset:96
    v_lshrrev_b32 v12, 3, v1
    v_lshrrev_b32 v13, 4, v1
    v_lshlrev_b32 v13, 1, v13
    v_and_b32 v14, 7, v1
    v_xor_b32 v13, v13, v14
    v_lshlrev_b32 v13, 4, v13
    v_mul_u32_u24 v12, 3072, v12
    v_add_u32 v8, v12, v13
    v_add_u32 v9, 23552, v8
    v_add_u32 v10, 47104, v8
    v_add_u32 v11, 70656, v8
    s_mov_b32 s66, 0x76543210
    s_mov_b32 s67, 0xfedcba98
    s_cmp_eq_u32 s79, 0
    s_cselect_b32 s66, 0x67543201, s66
    s_cselect_b32 s67, 0xfecdba98, s67
    s_cmp_eq_u32 s79, 1
    s_cselect_b32 s66, 0x86543120, s66
    s_cselect_b32 s67, 0xfdecba97, s67
    s_cmp_eq_u32 s79, 2
    s_cselect_b32 s66, 0x76542310, s66
    s_cselect_b32 s67, 0xefdcba89, s67
    s_cmp_eq_u32 s79, 3
    s_cselect_b32 s66, 0x76534210, s66
    s_cselect_b32 s67, 0xfedcb9a8, s67
    s_cmp_eq_u32 s79, 4
    s_cselect_b32 s66, 0x76453210, s66
    s_cselect_b32 s67, 0xfedcab98, s67
    s_cmp_eq_u32 s79, 5
    s_cselect_b32 s66, 0x75643210, s66
    s_cselect_b32 s67, 0xfedbca98, s67
    s_and_b32 s60, s29, 3
    s_lshl_b32 s81, s60, 12
    s_mul_i32 s80, s60, 98304
    s_lshl_b32 s60, s73, 7
    s_add_u32 s80, s80, s60
    v_mov_b32 v124, 0
    v_mov_b32 v125, 0
    v_mov_b32 v126, 0x3f803f80
    s_waitcnt vmcnt(4)
    s_cmp_lt_u32 s29, 4
    s_cbranch_scc1 L_B_noearly
    s_bfe_u32 s60, s66, 0x4000c
    s_mul_i32 s60, s60, 393216
    s_add_u32 m0, s81, 49152
    s_add_u32 s60, s60, s80
    buffer_load_dwordx4 v8, s[40:43], s60 offen offset:0 lds
    buffer_load_dwordx4 v9, s[40:43], s60 offen offset:1024 lds
    buffer_load_dwordx4 v10, s[40:43], s60 offen offset:2048 lds
    buffer_load_dwordx4 v11, s[40:43], s60 offen offset:3072 lds
    s_bfe_u32 s60, s66, 0x40010
    s_mul_i32 s60, s60, 393216
    s_add_u32 m0, s81, 65536
    s_add_u32 s60, s60, s80
    buffer_load_dwordx4 v8, s[40:43], s60 offen offset:0 lds
    buffer_load_dwordx4 v9, s[40:43], s60 offen offset:1024 lds
    buffer_load_dwordx4 v10, s[40:43], s60 offen offset:2048 lds
    buffer_load_dwordx4 v11, s[40:43], s60 offen offset:3072 lds
L_B_noearly:
    v_dot2c_f32_bf16 v124, v16, v126
    v_lshlrev_b32 v84, 16, v16
    v_dot2c_f32_bf16 v125, v16, v64
    v_and_b32 v85, 0xffff0000, v16
    v_dot2c_f32_bf16 v124, v17, v126
    v_lshlrev_b32 v86, 16, v17
    v_dot2c_f32_bf16 v125, v17, v65
    v_and_b32 v87, 0xffff0000, v17
    v_dot2c_f32_bf16 v124, v18, v126
    v_lshlrev_b32 v88, 16, v18
    v_dot2c_f32_bf16 v125, v18, v66
    v_and_b32 v89, 0xffff0000, v18
    v_dot2c_f32_bf16 v124, v19, v126
    v_lshlrev_b32 v90, 16, v19
    v_dot2c_f32_bf16 v125, v19, v67
    v_and_b32 v91, 0xffff0000, v19
    v_dot2c_f32_bf16 v124, v20, v126
    v_lshlrev_b32 v92, 16, v20
    v_dot2c_f32_bf16 v125, v20, v68
    v_and_b32 v93, 0xffff0000, v20
    v_dot2c_f32_bf16 v124, v21, v126
    v_lshlrev_b32 v94, 16, v21
    v_dot2c_f32_bf16 v125, v21, v69
    v_and_b32 v95, 0xffff0000, v21
    v_dot2c_f32_bf16 v124, v22, v126
    v_lshlrev_b32 v96, 16, v22
    v_dot2c_f32_bf16 v125, v22, v70
    v_and_b32 v97, 0xffff0000, v22
    v_dot2c_f32_bf16 v124, v23, v126
    v_lshlrev_b32 v98, 16, v23
    v_dot2c_f32_bf16 v125, v23, v71
    v_and_b32 v99, 0xffff0000, v23
    v_dot2c_f32_bf16 v124, v24, v126
    v_lshlrev_b32 v100, 16, v24
    v_dot2c_f32_bf16 v125, v24, v72
    v_and_b32 v101, 0xffff0000, v24
    v_dot2c_f32_bf16 v124, v25, v126
    v_lshlrev_b32 v102, 16, v25
    v_dot2c_f32_bf16 v125, v25, v73
    v_and_b32 v103, 0xffff0000, v25
    v_dot2c_f32_bf16 v124, v26, v126
    v_lshlrev_b32 v104, 16, v26
    v_dot2c_f32_bf16 v125, v26, v74
    v_and_b32 v105, 0xffff0000, v26
    v_dot2c_f32_bf16 v124, v27, v126
    v_lshlrev_b32 v106, 16, v27
    v_dot2c_f32_bf16 v125, v27, v75
    v_and_b32 v107, 0xffff0000, v27
    v_dot2c_f32_bf16 v124, v28, v126
    v_lshlrev_b32 v108, 16, v28
    v_dot2c_f32_bf16 v125, v28, v76
    v_and_b32 v109, 0xffff0000, v28
    v_dot2c_f32_bf16 v124, v29, v126
    v_lshlrev_b32 v110, 16, v29
    v_dot2c_f32_bf16 v125, v29, v77
    v_and_b32 v111, 0xffff0000, v29
    v_dot2c_f32_bf16 v124, v30, v126
    v_lshlrev_b32 v112, 16, v30
    v_dot2c_f32_bf16 v125, v30, v78
    v_and_b32 v113, 0xffff0000, v30
    v_dot2c_f32_bf16 v124, v31, v126
    v_lshlrev_b32 v114, 16, v31
    v_dot2c_f32_bf16 v125, v31, v79
    v_and_b32 v115, 0xffff0000, v31
    v_dot2c_f32_bf16 v124, v32, v126
    v_lshlrev_b32 v116, 16, v32
    v_dot2c_f32_bf16 v125, v32, v80
    v_and_b32 v117, 0xffff0000, v32
    v_dot2c_f32_bf16 v124, v33, v126
    v_lshlrev_b32 v118, 16, v33
    v_dot2c_f32_bf16 v125, v33, v81
    v_and_b32 v119, 0xffff0000, v33
    v_dot2c_f32_bf16 v124, v34, v126
    v_lshlrev_b32 v120, 16, v34
    v_dot2c_f32_bf16 v125, v34, v82
    v_and_b32 v121, 0xffff0000, v34
    v_dot2c_f32_bf16 v124, v35, v126
    v_lshlrev_b32 v122, 16, v35
    v_dot2c_f32_bf16 v125, v35, v83
    v_and_b32 v123, 0xffff0000, v35
    s_nop 1
    v_add_f32_dpp v124, v124, v124 quad_perm:[1,0,3,2] row_mask:0xf bank_mask:0xf
    v_add_f32_dpp v125, v125, v125 quad_perm:[1,0,3,2] row_mask:0xf bank_mask:0xf
    s_nop 0
    v_add_f32_dpp v124, v124, v124 quad_perm:[2,3,0,1] row_mask:0xf bank_mask:0xf
    v_add_f32_dpp v125, v125, v125 quad_perm:[2,3,0,1] row_mask:0xf bank_mask:0xf
    s_nop 0
    v_add_f32_dpp v124, v124, v124 row_half_mirror row_mask:0xf bank_mask:0xf
    v_add_f32_dpp v125, v125, v125 row_half_mirror row_mask:0xf bank_mask:0xf
    s_nop 0
    v_add_f32_dpp v124, v124, v124 row_mirror row_mask:0xf bank_mask:0xf
    v_add_f32_dpp v125, v125, v125 row_mirror row_mask:0xf bank_mask:0xf
    s_nop 0
    v_mul_f32 v126, 0xbacccccd, v124
    v_mul_f32 v127, 0xbacccccd, v124
    v_mul_f32 v125, 0xbfb8aa3b, v125
    v_mov_b32 v128, 0
    v_mov_b32 v129, 0
    v_mov_b32 v130, 0
    v_mov_b32 v131, 0
    v_mov_b32 v132, 0
    v_mov_b32 v133, 0
    v_mov_b32 v134, 0
    v_mov_b32 v135, 0
    v_exp_f32 v125, v125
    v_pk_add_f32 v[84:85], v[84:85], v[126:127]
    v_pk_add_f32 v[86:87], v[86:87], v[126:127]
    v_pk_add_f32 v[88:89], v[88:89], v[126:127]
    v_pk_add_f32 v[90:91], v[90:91], v[126:127]
    v_pk_add_f32 v[92:93], v[92:93], v[126:127]
    v_pk_add_f32 v[94:95], v[94:95], v[126:127]
    v_pk_add_f32 v[96:97], v[96:97], v[126:127]
    v_pk_add_f32 v[98:99], v[98:99], v[126:127]
    v_pk_add_f32 v[100:101], v[100:101], v[126:127]
    v_pk_add_f32 v[102:103], v[102:103], v[126:127]
    v_pk_add_f32 v[104:105], v[104:105], v[126:127]
    v_pk_add_f32 v[106:107], v[106:107], v[126:127]
    v_pk_add_f32 v[108:109], v[108:109], v[126:127]
    v_pk_add_f32 v[110:111], v[110:111], v[126:127]
    v_pk_add_f32 v[112:113], v[112:113], v[126:127]
    v_pk_add_f32 v[114:115], v[114:115], v[126:127]
    v_pk_add_f32 v[116:117], v[116:117], v[126:127]
    v_pk_add_f32 v[118:119], v[118:119], v[126:127]
    v_pk_add_f32 v[120:121], v[120:121], v[126:127]
    v_pk_add_f32 v[122:123], v[122:123], v[126:127]
    v_add_f32 v125, 1.0, v125
    v_rcp_f32 v125, v125
    v_pk_fma_f32 v[128:129], v[84:85], v[84:85], v[128:129]
    v_pk_fma_f32 v[130:131], v[86:87], v[86:87], v[130:131]
    v_pk_fma_f32 v[132:133], v[88:89], v[88:89], v[132:133]
    v_pk_fma_f32 v[134:135], v[90:91], v[90:91], v[134:135]
    v_pk_fma_f32 v[128:129], v[92:93], v[92:93], v[128:129]
    v_pk_fma_f32 v[130:131], v[94:95], v[94:95], v[130:131]
    v_pk_fma_f32 v[132:133], v[96:97], v[96:97], v[132:133]
    v_pk_fma_f32 v[134:135], v[98:99], v[98:99], v[134:135]
    v_pk_fma_f32 v[128:129], v[100:101], v[100:101], v[128:129]
    v_pk_fma_f32 v[130:131], v[102:103], v[102:103], v[130:131]
    v_pk_fma_f32 v[132:133], v[104:105], v[104:105], v[132:133]
    v_pk_fma_f32 v[134:135], v[106:107], v[106:107], v[134:135]
    v_pk_fma_f32 v[128:129], v[108:109], v[108:109], v[128:129]
    v_pk_fma_f32 v[130:131], v[110:111], v[110:111], v[130:131]
    v_pk_fma_f32 v[132:133], v[112:113], v[112:113], v[132:133]
    v_pk_fma_f32 v[134:135], v[114:115], v[114:115], v[134:135]
    v_pk_fma_f32 v[128:129], v[116:117], v[116:117], v[128:129]
    v_pk_fma_f32 v[130:131], v[118:119], v[118:119], v[130:131]
    v_pk_fma_f32 v[132:133], v[120:121], v[120:121], v[132:133]
    v_pk_fma_f32 v[134:135], v[122:123], v[122:123], v[134:135]
    v_pk_add_f32 v[128:129], v[128:129], v[130:131]
    v_pk_add_f32 v[132:133], v[132:133], v[134:135]
    v_pk_add_f32 v[128:129], v[128:129], v[132:133]
    v_add_f32 v128, v128, v129
    s_nop 1
    v_add_f32_dpp v128, v128, v128 quad_perm:[1,0,3,2] row_mask:0xf bank_mask:0xf
    s_nop 1
    v_add_f32_dpp v128, v128, v128 quad_perm:[2,3,0,1] row_mask:0xf bank_mask:0xf
    s_nop 1
    v_add_f32_dpp v128, v128, v128 row_half_mirror row_mask:0xf bank_mask:0xf
    s_nop 1
    v_add_f32_dpp v128, v128, v128 row_mirror row_mask:0xf bank_mask:0xf
    s_nop 1
    v_mov_b32 v126, 0x3727c5ac
    v_fmac_f32 v126, 0x3acccccd, v128
    v_rsq_f32 v126, v126
    s_lshl_b32 s60, s29, 2
    v_add_u32 v2, s60, v2
    v_mov_b32 v127, v126
    v_mul_u32_u24 v4, 1312, v2
    v_add_u32 v4, v4, v3
    v_lshlrev_b32 v2, 2, v2
    v_pk_mul_f32 v[84:85], v[84:85], v[126:127]
    v_pk_mul_f32 v[86:87], v[86:87], v[126:127]
    v_pk_mul_f32 v[88:89], v[88:89], v[126:127]
    v_pk_mul_f32 v[90:91], v[90:91], v[126:127]
    v_cvt_pk_bf16_f32 v16, v84, v85
    v_cvt_pk_bf16_f32 v17, v86, v87
    v_cvt_pk_bf16_f32 v18, v88, v89
    v_cvt_pk_bf16_f32 v19, v90, v91
    ds_write_b128 v4, v[16:19] offset:0
    v_pk_mul_f32 v[92:93], v[92:93], v[126:127]
    v_pk_mul_f32 v[94:95], v[94:95], v[126:127]
    v_pk_mul_f32 v[96:97], v[96:97], v[126:127]
    v_pk_mul_f32 v[98:99], v[98:99], v[126:127]
    v_cvt_pk_bf16_f32 v20, v92, v93
    v_cvt_pk_bf16_f32 v21, v94, v95
    v_cvt_pk_bf16_f32 v22, v96, v97
    v_cvt_pk_bf16_f32 v23, v98, v99
    ds_write_b128 v4, v[20:23] offset:256
    v_pk_mul_f32 v[100:101], v[100:101], v[126:127]
    v_pk_mul_f32 v[102:103], v[102:103], v[126:127]
    v_pk_mul_f32 v[104:105], v[104:105], v[126:127]
    v_pk_mul_f32 v[106:107], v[106:107], v[126:127]
    v_cvt_pk_bf16_f32 v24, v100, v101
    v_cvt_pk_bf16_f32 v25, v102, v103
    v_cvt_pk_bf16_f32 v26, v104, v105
    v_cvt_pk_bf16_f32 v27, v106, v107
    ds_write_b128 v4, v[24:27] offset:512
    v_pk_mul_f32 v[108:109], v[108:109], v[126:127]
    v_pk_mul_f32 v[110:111], v[110:111], v[126:127]
    v_pk_mul_f32 v[112:113], v[112:113], v[126:127]
    v_pk_mul_f32 v[114:115], v[114:115], v[126:127]
    v_cvt_pk_bf16_f32 v28, v108, v109
    v_cvt_pk_bf16_f32 v29, v110, v111
    v_cvt_pk_bf16_f32 v30, v112, v113
    v_cvt_pk_bf16_f32 v31, v114, v115
    ds_write_b128 v4, v[28:31] offset:768
    v_pk_mul_f32 v[116:117], v[116:117], v[126:127]
    v_pk_mul_f32 v[118:119], v[118:119], v[126:127]
    v_pk_mul_f32 v[120:121], v[120:121], v[126:127]
    v_pk_mul_f32 v[122:123], v[122:123], v[126:127]
    v_cvt_pk_bf16_f32 v32, v116, v117
    v_cvt_pk_bf16_f32 v33, v118, v119
    v_cvt_pk_bf16_f32 v34, v120, v121
    v_cvt_pk_bf16_f32 v35, v122, v123
    ds_write_b128 v4, v[32:35] offset:1024
    ds_write_b32 v2, v125 offset:41984
    v_and_b32 v12, 15, v1
    v_lshrrev_b32 v13, 4, v1
    v_lshrrev_b32 v15, 2, v12
    v_lshl_add_u32 v15, v13, 2, v15
    v_mul_u32_u24 v15, 1312, v15
    v_and_b32 v2, 3, v12
    v_lshl_add_u32 v15, v2, 3, v15
    s_mul_i32 s60, s29, 160
    v_add_u32 v15, s60, v15
    v_lshlrev_b32 v14, 4, v1
    v_lshlrev_b32 v2, 2, v1
    s_mul_i32 s60, s29, 327680
    s_lshl_b32 s61, s74, 10
    s_add_u32 s60, s60, s61
    s_add_u32 s60, s60, 1048576
    s_waitcnt lgkmcnt(0)
    s_add_u32 s28, s28, 0x9e3779b9
    s_barrier
    ds_read_b64_tr_b16 v[44:45], v15 offset:0
    ds_read_b64_tr_b16 v[46:47], v15 offset:20992
    ds_read_b64_tr_b16 v[48:49], v15 offset:32
    ds_read_b64_tr_b16 v[50:51], v15 offset:21024
    ds_read_b64_tr_b16 v[52:53], v15 offset:64
    ds_read_b64_tr_b16 v[54:55], v15 offset:21056
    ds_read_b64_tr_b16 v[56:57], v15 offset:96
    ds_read_b64_tr_b16 v[58:59], v15 offset:21088
    ds_read_b64_tr_b16 v[60:61], v15 offset:128
    ds_read_b64_tr_b16 v[62:63], v15 offset:21120
    ds_read_b32 v125, v2 offset:41984
    s_waitcnt lgkmcnt(9)
    buffer_store_dwordx4 v[44:47], v14, s[32:35], s60 offen sc1
    s_add_u32 s60, s60, 65536
    s_waitcnt lgkmcnt(7)
    buffer_store_dwordx4 v[48:51], v14, s[32:35], s60 offen sc1
    s_add_u32 s60, s60, 65536
    s_waitcnt lgkmcnt(5)
    buffer_store_dwordx4 v[52:55], v14, s[32:35], s60 offen sc1
    s_add_u32 s60, s60, 65536
    s_waitcnt lgkmcnt(3)
    buffer_store_dwordx4 v[56:59], v14, s[32:35], s60 offen sc1
    s_add_u32 s60, s60, 65536
    s_waitcnt lgkmcnt(1)
    buffer_store_dwordx4 v[60:63], v14, s[32:35], s60 offen sc1
    s_cmp_lg_u32 s29, 0
    s_cbranch_scc1 L_B_nog
    s_lshl_b32 s60, s74, 7
    s_add_u32 s60, s60, 73728
    s_waitcnt lgkmcnt(0)
    s_mov_b32 exec_hi, 0
    buffer_store_dword v125, v2, s[32:35], s60 offen sc1
    s_mov_b32 exec_hi, -1
L_B_nog:
    s_mul_i32 s60, s74, 128
    s_add_u32 s60, s60, 4096
    v_mov_b32 v12, s28
    v_mov_b32 v13, 0
    s_cmp_lg_u32 s29, 0
    s_waitcnt vmcnt(0) lgkmcnt(0)
    s_barrier
    s_cbranch_scc1 L_B_nofl
    s_mov_b64 exec, 1
    buffer_store_dword v12, v13, s[32:35], s60 offen sc1
    s_mov_b64 exec, -1
L_B_nofl:
    s_mov_b32 s52, s8
    s_and_b32 s53, s9, 0xffff
    s_mov_b32 s54, 0xc8000
    s_mov_b32 s55, 0x20000
    s_lshl_b32 s61, s74, 3
    s_add_u32 s61, s61, s29
    s_mul_i32 s61, s61, 1664
    v_lshlrev_b32 v6, 7, v1
    s_mov_b64 exec, 0x1fff
    buffer_load_dword v253, v6, s[52:55], s61 offen
    s_mov_b64 exec, -1
    s_lshl_b32 s61, s74, 3
    s_add_u32 s61, s61, s29
    s_mul_i32 s61, s61, 1024
    s_add_u32 s61, s61, 4194304
    s_mov_b32 exec_hi, 0
    s_mov_b32 exec_lo, 0xff
    buffer_load_dword v253, v6, s[48:51], s61 offen
    s_mov_b64 exec, -1
    s_branch L_B_join
L_B_pfrole:
    s_mov_b32 s40, s12
    s_and_b32 s41, s13, 0xffff
    s_mov_b32 s42, 0x600000
    s_mov_b32 s43, 0x20000
    s_mov_b32 s52, s20
    s_and_b32 s53, s21, 0xffff
    s_mov_b32 s54, 0x500
    s_mov_b32 s55, 0x20000
    s_cmp_ge_u32 s29, 1
    s_cbranch_scc1 L_B_noxh
    s_lshl_b32 s60, s30, 4
    s_add_u32 s60, s60, s31
    s_sub_u32 s60, s60, 16
    s_mul_i32 s60, s60, 40960
    s_lshl_b32 s61, s29, 8
    s_sub_u32 s60, s60, s61
    s_add_u32 s60, s60, 1024
    v_lshrrev_b32 v6, 1, v1
    v_and_b32 v7, 1, v1
    v_mul_u32_u24 v6, 1280, v6
    v_lshl_add_u32 v6, v7, 7, v6
    buffer_load_dword v253, v6, s[36:39], s60 offen
    v_lshlrev_b32 v6, 7, v1
L_B_noxh:
    s_cmp_lg_u32 s29, 7
    s_cbranch_scc1 L_B_noxg
    v_lshlrev_b32 v6, 7, v1
    buffer_load_dword v253, v6, s[52:55], 0 offen
L_B_noxg:
    s_sub_u32 s60, s31, 16
    s_lshl_b32 s60, s60, 3
    s_add_u32 s60, s60, s29
    s_lshl_b32 s61, s30, 7
    s_add_u32 s61, s61, s60
    v_lshrrev_b32 v6, 3, v1
    v_and_b32 v7, 7, v1
    v_min_u32 v7, 5, v7
    v_mul_u32_u24 v6, 3072, v6
    v_lshl_add_u32 v7, v7, 7, v6
    s_mul_i32 s60, s60, 24576
    s_mul_i32 s62, s30, 768
    s_add_u32 s60, s60, s62
    buffer_load_dword v253, v7, s[40:43], s60 offen
    s_mov_b32 s52, s6
    s_and_b32 s53, s7, 0xffff
    s_mov_b32 s54, 0x258000
    s_mov_b32 s55, 0x20000
    v_lshlrev_b32 v6, 7, v1
    s_mul_i32 s61, s61, 2880
    s_add_u32 s61, s61, 983040
    s_mov_b64 exec, 0xffffff
    buffer_load_dword v253, v6, s[52:55], s61 offen
    s_mov_b64 exec, -1
    s_add_u32 s60, s60, 3145728
    buffer_load_dword v253, v7, s[40:43], s60 offen
    s_mul_i32 s79, s31, 205
    s_lshr_b32 s79, s79, 10
    s_mul_i32 s72, s79, 5
    s_sub_u32 s72, s31, s72
    s_mul_i32 s73, s30, 6
    s_add_u32 s73, s73, s79
    s_mov_b32 s56, s14
    s_and_b32 s57, s15, 0xffff
    s_mov_b32 s58, 0xc00
    s_mov_b32 s59, 0x20000
    v_lshrrev_b32 v5, 4, v1
    v_lshlrev_b32 v5, 3, v5
    s_lshl_b32 s60, s73, 7
    buffer_load_dwordx2 v[36:37], v5, s[56:59], s60 offen offset:0
    buffer_load_dwordx2 v[38:39], v5, s[56:59], s60 offen offset:32
    buffer_load_dwordx2 v[40:41], v5, s[56:59], s60 offen offset:64
    buffer_load_dwordx2 v[42:43], v5, s[56:59], s60 offen offset:96
    v_lshrrev_b32 v12, 3, v1
    v_lshrrev_b32 v13, 4, v1
    v_lshlrev_b32 v13, 1, v13
    v_and_b32 v14, 7, v1
    v_xor_b32 v13, v13, v14
    v_lshlrev_b32 v13, 4, v13
    v_mul_u32_u24 v12, 3072, v12
    v_add_u32 v8, v12, v13
    v_add_u32 v9, 23552, v8
    v_add_u32 v10, 47104, v8
    v_add_u32 v11, 70656, v8
    s_mov_b32 s66, 0x76543210
    s_mov_b32 s67, 0xfedcba98
    s_cmp_eq_u32 s79, 0
    s_cselect_b32 s66, 0x67543201, s66
    s_cselect_b32 s67, 0xfecdba98, s67
    s_cmp_eq_u32 s79, 1
    s_cselect_b32 s66, 0x86543120, s66
    s_cselect_b32 s67, 0xfdecba97, s67
    s_cmp_eq_u32 s79, 2
    s_cselect_b32 s66, 0x76542310, s66
    s_cselect_b32 s67, 0xefdcba89, s67
    s_cmp_eq_u32 s79, 3
    s_cselect_b32 s66, 0x76534210, s66
    s_cselect_b32 s67, 0xfedcb9a8, s67
    s_cmp_eq_u32 s79, 4
    s_cselect_b32 s66, 0x76453210, s66
    s_cselect_b32 s67, 0xfedcab98, s67
    s_cmp_eq_u32 s79, 5
    s_cselect_b32 s66, 0x75643210, s66
    s_cselect_b32 s67, 0xfedbca98, s67
    s_and_b32 s60, s29, 3
    s_lshl_b32 s81, s60, 12
    s_mul_i32 s80, s60, 98304
    s_lshl_b32 s60, s73, 7
    s_add_u32 s80, s80, s60
    s_waitcnt lgkmcnt(0)
    s_add_u32 s28, s28, 0x9e3779b9
    s_cmp_ge_u32 s31, 30
    s_cbranch_scc1 L_helper
L_B_join:
    s_cmp_lt_u32 s29, 4
    s_cbranch_scc1 L_B_comp0
    s_bfe_u32 s60, s66, 0x40000
    s_mul_i32 s60, s60, 393216
    s_add_u32 m0, s81, 0
    s_add_u32 s60, s60, s80
    buffer_load_dwordx4 v8, s[40:43], s60 offen offset:0 lds
    buffer_load_dwordx4 v9, s[40:43], s60 offen offset:1024 lds
    buffer_load_dwordx4 v10, s[40:43], s60 offen offset:2048 lds
    buffer_load_dwordx4 v11, s[40:43], s60 offen offset:3072 lds
    s_bfe_u32 s60, s66, 0x40004
    s_mul_i32 s60, s60, 393216
    s_add_u32 m0, s81, 16384
    s_add_u32 s60, s60, s80
    buffer_load_dwordx4 v8, s[40:43], s60 offen offset:0 lds
    buffer_load_dwordx4 v9, s[40:43], s60 offen offset:1024 lds
    buffer_load_dwordx4 v10, s[40:43], s60 offen offset:2048 lds
    buffer_load_dwordx4 v11, s[40:43], s60 offen offset:3072 lds
    s_bfe_u32 s60, s66, 0x40008
    s_mul_i32 s60, s60, 393216
    s_add_u32 m0, s81, 32768
    s_add_u32 s60, s60, s80
    buffer_load_dwordx4 v8, s[40:43], s60 offen offset:0 lds
    buffer_load_dwordx4 v9, s[40:43], s60 offen offset:1024 lds
    buffer_load_dwordx4 v10, s[40:43], s60 offen offset:2048 lds
    buffer_load_dwordx4 v11, s[40:43], s60 offen offset:3072 lds
    s_cmp_lt_u32 s31, 16
    s_cbranch_scc1 L_B_skipearly
    s_bfe_u32 s60, s66, 0x4000c
    s_mul_i32 s60, s60, 393216
    s_add_u32 m0, s81, 49152
    s_add_u32 s60, s60, s80
    buffer_load_dwordx4 v8, s[40:43], s60 offen offset:0 lds
    buffer_load_dwordx4 v9, s[40:43], s60 offen offset:1024 lds
    buffer_load_dwordx4 v10, s[40:43], s60 offen offset:2048 lds
    buffer_load_dwordx4 v11, s[40:43], s60 offen offset:3072 lds
    s_bfe_u32 s60, s66, 0x40010
    s_mul_i32 s60, s60, 393216
    s_add_u32 m0, s81, 65536
    s_add_u32 s60, s60, s80
    buffer_load_dwordx4 v8, s[40:43], s60 offen offset:0 lds
    buffer_load_dwordx4 v9, s[40:43], s60 offen offset:1024 lds
    buffer_load_dwordx4 v10, s[40:43], s60 offen offset:2048 lds
    buffer_load_dwordx4 v11, s[40:43], s60 offen offset:3072 lds
L_B_skipearly:
    s_bfe_u32 s60, s66, 0x40014
    s_mul_i32 s60, s60, 393216
    s_add_u32 m0, s81, 81920
    s_add_u32 s60, s60, s80
    buffer_load_dwordx4 v8, s[40:43], s60 offen offset:0 lds
    buffer_load_dwordx4 v9, s[40:43], s60 offen offset:1024 lds
    buffer_load_dwordx4 v10, s[40:43], s60 offen offset:2048 lds
    buffer_load_dwordx4 v11, s[40:43], s60 offen offset:3072 lds
    s_bfe_u32 s60, s66, 0x40018
    s_mul_i32 s60, s60, 393216
    s_add_u32 m0, s81, 98304
    s_add_u32 s60, s60, s80
    buffer_load_dwordx4 v8, s[40:43], s60 offen offset:0 lds
    buffer_load_dwordx4 v9, s[40:43], s60 offen offset:1024 lds
    buffer_load_dwordx4 v10, s[40:43], s60 offen offset:2048 lds
    buffer_load_dwordx4 v11, s[40:43], s60 offen offset:3072 lds
    s_bfe_u32 s60, s66, 0x4001c
    s_mul_i32 s60, s60, 393216
    s_add_u32 m0, s81, 114688
    s_add_u32 s60, s60, s80
    buffer_load_dwordx4 v8, s[40:43], s60 offen offset:0 lds
    buffer_load_dwordx4 v9, s[40:43], s60 offen offset:1024 lds
    buffer_load_dwordx4 v10, s[40:43], s60 offen offset:2048 lds
    buffer_load_dwordx4 v11, s[40:43], s60 offen offset:3072 lds
    s_mov_b32 s66, s67
    s_branch L_B_aux
L_B_comp0:
    s_lshl_b32 s60, s72, 3
    s_lshl_b32 s61, s29, 1
    s_add_u32 s83, s60, s61
    s_lshl_b32 s60, s83, 16
    s_add_u32 s60, s60, 1048576
    s_add_u32 s44, s26, s60
    s_addc_u32 s45, s27, 0
    s_and_b32 s45, s45, 0xffff
    s_mov_b32 s46, 0x10000
    s_mov_b32 s47, 0x20000
    s_add_u32 s60, s60, 65536
    s_add_u32 s52, s26, s60
    s_addc_u32 s53, s27, 0
    s_and_b32 s53, s53, 0xffff
    s_mov_b32 s54, 0x10000
    s_mov_b32 s55, 0x20000
    v_lshlrev_b32 v12, 4, v1
    s_mov_b32 s81, 0
    s_and_b32 s82, s66, 15
    s_lshr_b64 s[66:67], s[66:67], 4
    s_lshl_b32 s82, s82, 12
    v_and_b32 v9, 15, v1
    v_lshrrev_b32 v10, 4, v1
    v_lshrrev_b32 v11, 2, v9
    v_lshl_add_u32 v11, v10, 2, v11
    v_bfe_u32 v10, v11, 1, 2
    v_lshlrev_b32 v11, 7, v11
    v_lshl_add_u32 v11, v10, 5, v11
    v_and_b32 v9, 3, v9
    v_lshl_add_u32 v8, v9, 3, v11
    v_xor_b32 v9, 32, v8
    v_xor_b32 v10, 64, v8
    v_xor_b32 v11, 96, v8
    s_waitcnt vmcnt(0)
    s_mov_b32 s90, 0xbdd2d3e8
    s_mov_b32 s91, 0xbdd2d3e8
    v_mov_b32 v44, 0xc0135761
    v_mov_b32 v45, 0xc0135761
    v_mov_b32 v46, 1.0
    v_mov_b32 v47, 1.0
    s_lshl_b32 s92, s72, 3
    s_lshl_b32 s61, s29, 1
    s_add_u32 s92, s92, s61
    s_add_u32 s92, s92, 0x0
    s_mul_i32 s92, s92, 69632
    s_lshl_b32 s61, s73, 11
    s_add_u32 s92, s92, s61
    s_add_u32 s92, s92, 3670016
    v_lshlrev_b32 v16, 16, v36
    v_and_b32 v17, 0xffff0000, v36
    v_lshlrev_b32 v18, 16, v37
    v_and_b32 v19, 0xffff0000, v37
    v_lshlrev_b32 v20, 16, v38
    v_and_b32 v21, 0xffff0000, v38
    v_lshlrev_b32 v22, 16, v39
    v_and_b32 v23, 0xffff0000, v39
    v_lshlrev_b32 v24, 16, v40
    v_and_b32 v25, 0xffff0000, v40
    v_lshlrev_b32 v26, 16, v41
    v_and_b32 v27, 0xffff0000, v41
    v_lshlrev_b32 v28, 16, v42
    v_and_b32 v29, 0xffff0000, v42
    v_lshlrev_b32 v30, 16, v43
    v_and_b32 v31, 0xffff0000, v43
    v_mov_b32 v160, v16
    v_mov_b32 v161, v17
    v_mov_b32 v162, v18
    v_mov_b32 v163, v19
    v_mov_b32 v164, v20
    v_mov_b32 v165, v21
    v_mov_b32 v166, v22
    v_mov_b32 v167, v23
    v_mov_b32 v168, v24
    v_mov_b32 v169, v25
    v_mov_b32 v170, v26
    v_mov_b32 v171, v27
    v_mov_b32 v172, v28
    v_mov_b32 v173, v29
    v_mov_b32 v174, v30
    v_mov_b32 v175, v31
    v_mov_b32 v176, v16
    v_mov_b32 v177, v17
    v_mov_b32 v178, v18
    v_mov_b32 v179, v19
    v_mov_b32 v180, v20
    v_mov_b32 v181, v21
    v_mov_b32 v182, v22
    v_mov_b32 v183, v23
    v_mov_b32 v184, v24
    v_mov_b32 v185, v25
    v_mov_b32 v186, v26
    v_mov_b32 v187, v27
    v_mov_b32 v188, v28
    v_mov_b32 v189, v29
    v_mov_b32 v190, v30
    v_mov_b32 v191, v31
    s_lshl_b32 s60, s29, 12
    s_add_u32 s60, s60, 131072
    v_add_u32 v13, s60, v12
    s_cmp_lg_u32 s29, 0
    s_cbranch_scc1 L_B_l3
    v_min_u32 v2, 19, v1
    v_mul_u32_u24 v2, 128, v2
    v_add_u32 v2, 4096, v2
    s_mov_b32 s78, 0
Lpoll_8:
    buffer_load_dword v4, v2, s[32:35], 0 offen sc1
    s_waitcnt vmcnt(0)
    v_cmp_ne_u32 vcc, s28, v4
    s_nop 1
    s_cmp_eq_u64 vcc, 0
    s_cbranch_scc1 Lpdone_9
    s_add_u32 s78, s78, 1
    s_cmp_lt_u32 s78, 131072
    s_cbranch_scc0 Lpdone_9
    s_sleep 1
    s_branch Lpoll_8
Lpdone_9:
L_B_l3:
    s_barrier
    buffer_load_dwordx4 v[64:67], v12, s[44:47], s82 offen offset:0 sc1
    buffer_load_dwordx4 v[68:71], v12, s[52:55], s82 offen offset:0 sc1
    buffer_load_dwordx4 v[72:75], v12, s[44:47], s82 offen offset:1024 sc1
    buffer_load_dwordx4 v[76:79], v12, s[52:55], s82 offen offset:1024 sc1
    buffer_load_dwordx4 v[80:83], v12, s[44:47], s82 offen offset:2048 sc1
    buffer_load_dwordx4 v[84:87], v12, s[52:55], s82 offen offset:2048 sc1
    buffer_load_dwordx4 v[88:91], v12, s[44:47], s82 offen offset:3072 sc1
    buffer_load_dwordx4 v[92:95], v12, s[52:55], s82 offen offset:3072 sc1
    s_and_b32 s82, s66, 15
    s_lshr_b64 s[66:67], s[66:67], 4
    s_lshl_b32 s82, s82, 12
    s_barrier
    buffer_load_dwordx4 v[96:99], v12, s[44:47], s82 offen offset:0 sc1
    buffer_load_dwordx4 v[100:103], v12, s[52:55], s82 offen offset:0 sc1
    buffer_load_dwordx4 v[104:107], v12, s[44:47], s82 offen offset:1024 sc1
    buffer_load_dwordx4 v[108:111], v12, s[52:55], s82 offen offset:1024 sc1
    buffer_load_dwordx4 v[112:115], v12, s[44:47], s82 offen offset:2048 sc1
    buffer_load_dwordx4 v[116:119], v12, s[52:55], s82 offen offset:2048 sc1
    buffer_load_dwordx4 v[120:123], v12, s[44:47], s82 offen offset:3072 sc1
    buffer_load_dwordx4 v[124:127], v12, s[52:55], s82 offen offset:3072 sc1
    s_and_b32 s82, s66, 15
    s_lshr_b64 s[66:67], s[66:67], 4
    s_lshl_b32 s82, s82, 12
    ds_read_b64_tr_b16 v[128:129], v8 offset:0
    ds_read_b64_tr_b16 v[130:131], v8 offset:2048
    ds_read_b64_tr_b16 v[132:133], v9 offset:0
    ds_read_b64_tr_b16 v[134:135], v9 offset:2048
    ds_read_b64_tr_b16 v[136:137], v10 offset:0
    ds_read_b64_tr_b16 v[138:139], v10 offset:2048
    ds_read_b64_tr_b16 v[140:141], v11 offset:0
    ds_read_b64_tr_b16 v[142:143], v11 offset:2048
    ds_read_b64_tr_b16 v[144:145], v8 offset:4096
    ds_read_b64_tr_b16 v[146:147], v8 offset:6144
    ds_read_b64_tr_b16 v[148:149], v9 offset:4096
    ds_read_b64_tr_b16 v[150:151], v9 offset:6144
    ds_read_b64_tr_b16 v[152:153], v10 offset:4096
    ds_read_b64_tr_b16 v[154:155], v10 offset:6144
L_B_loop:
    s_waitcnt vmcnt(14) lgkmcnt(10)
    v_mfma_f32_16x16x32_bf16 v[160:163], v[128:131], v[64:67], v[160:163]
    ds_read_b64_tr_b16 v[156:157], v11 offset:4096
    v_mfma_f32_16x16x32_bf16 v[176:179], v[128:131], v[68:71], v[176:179]
    ds_read_b64_tr_b16 v[158:159], v11 offset:6144
    v_mfma_f32_16x16x32_bf16 v[164:167], v[132:135], v[64:67], v[164:167]
    ds_read_b64_tr_b16 v[128:129], v8 offset:8192
    v_mfma_f32_16x16x32_bf16 v[180:183], v[132:135], v[68:71], v[180:183]
    ds_read_b64_tr_b16 v[130:131], v8 offset:10240
    s_waitcnt lgkmcnt(10)
    v_mfma_f32_16x16x32_bf16 v[168:171], v[136:139], v[64:67], v[168:171]
    ds_read_b64_tr_b16 v[132:133], v9 offset:8192
    v_mfma_f32_16x16x32_bf16 v[184:187], v[136:139], v[68:71], v[184:187]
    ds_read_b64_tr_b16 v[134:135], v9 offset:10240
    v_mfma_f32_16x16x32_bf16 v[172:175], v[140:143], v[64:67], v[172:175]
    ds_read_b64_tr_b16 v[136:137], v10 offset:8192
    v_mfma_f32_16x16x32_bf16 v[188:191], v[140:143], v[68:71], v[188:191]
    ds_read_b64_tr_b16 v[138:139], v10 offset:10240
    s_waitcnt vmcnt(12) lgkmcnt(10)
    v_mfma_f32_16x16x32_bf16 v[160:163], v[144:147], v[72:75], v[160:163]
    buffer_load_dwordx4 v[64:67], v12, s[44:47], s82 offen offset:0 sc1
    ds_read_b64_tr_b16 v[140:141], v11 offset:8192
    v_mfma_f32_16x16x32_bf16 v[176:179], v[144:147], v[76:79], v[176:179]
    buffer_load_dwordx4 v[68:71], v12, s[52:55], s82 offen offset:0 sc1
    ds_read_b64_tr_b16 v[142:143], v11 offset:10240
    v_mfma_f32_16x16x32_bf16 v[164:167], v[148:151], v[72:75], v[164:167]
    ds_read_b64_tr_b16 v[144:145], v8 offset:12288
    v_mfma_f32_16x16x32_bf16 v[180:183], v[148:151], v[76:79], v[180:183]
    ds_read_b64_tr_b16 v[146:147], v8 offset:14336
    s_waitcnt lgkmcnt(10)
    v_mfma_f32_16x16x32_bf16 v[168:171], v[152:155], v[72:75], v[168:171]
    ds_read_b64_tr_b16 v[148:149], v9 offset:12288
    v_mfma_f32_16x16x32_bf16 v[184:187], v[152:155], v[76:79], v[184:187]
    ds_read_b64_tr_b16 v[150:151], v9 offset:14336
    v_mfma_f32_16x16x32_bf16 v[172:175], v[156:159], v[72:75], v[172:175]
    ds_read_b64_tr_b16 v[152:153], v10 offset:12288
    v_mfma_f32_16x16x32_bf16 v[188:191], v[156:159], v[76:79], v[188:191]
    ds_read_b64_tr_b16 v[154:155], v10 offset:14336
    s_waitcnt vmcnt(12) lgkmcnt(10)
    v_mfma_f32_16x16x32_bf16 v[160:163], v[128:131], v[80:83], v[160:163]
    buffer_load_dwordx4 v[72:75], v12, s[44:47], s82 offen offset:1024 sc1
    ds_read_b64_tr_b16 v[156:157], v11 offset:12288
    v_mfma_f32_16x16x32_bf16 v[176:179], v[128:131], v[84:87], v[176:179]
    buffer_load_dwordx4 v[76:79], v12, s[52:55], s82 offen offset:1024 sc1
    ds_read_b64_tr_b16 v[158:159], v11 offset:14336
    s_barrier
    v_mfma_f32_16x16x32_bf16 v[164:167], v[132:135], v[80:83], v[164:167]
    ds_read_b64_tr_b16 v[128:129], v8 offset:16384
    v_mfma_f32_16x16x32_bf16 v[180:183], v[132:135], v[84:87], v[180:183]
    ds_read_b64_tr_b16 v[130:131], v8 offset:18432
    s_waitcnt lgkmcnt(10)
    v_mfma_f32_16x16x32_bf16 v[168:171], v[136:139], v[80:83], v[168:171]
    ds_read_b64_tr_b16 v[132:133], v9 offset:16384
    v_mfma_f32_16x16x32_bf16 v[184:187], v[136:139], v[84:87], v[184:187]
    ds_read_b64_tr_b16 v[134:135], v9 offset:18432
    v_mfma_f32_16x16x32_bf16 v[172:175], v[140:143], v[80:83], v[172:175]
    ds_read_b64_tr_b16 v[136:137], v10 offset:16384
    v_mfma_f32_16x16x32_bf16 v[188:191], v[140:143], v[84:87], v[188:191]
    ds_read_b64_tr_b16 v[138:139], v10 offset:18432
    s_waitcnt vmcnt(12) lgkmcnt(10)
    v_mfma_f32_16x16x32_bf16 v[160:163], v[144:147], v[88:91], v[160:163]
    buffer_load_dwordx4 v[80:83], v12, s[44:47], s82 offen offset:2048 sc1
    ds_read_b64_tr_b16 v[140:141], v11 offset:16384
    v_mfma_f32_16x16x32_bf16 v[176:179], v[144:147], v[92:95], v[176:179]
    buffer_load_dwordx4 v[84:87], v12, s[52:55], s82 offen offset:2048 sc1
    ds_read_b64_tr_b16 v[142:143], v11 offset:18432
    v_mfma_f32_16x16x32_bf16 v[164:167], v[148:151], v[88:91], v[164:167]
    ds_read_b64_tr_b16 v[144:145], v8 offset:20480
    v_mfma_f32_16x16x32_bf16 v[180:183], v[148:151], v[92:95], v[180:183]
    ds_read_b64_tr_b16 v[146:147], v8 offset:22528
    s_waitcnt lgkmcnt(10)
    v_mfma_f32_16x16x32_bf16 v[168:171], v[152:155], v[88:91], v[168:171]
    ds_read_b64_tr_b16 v[148:149], v9 offset:20480
    v_mfma_f32_16x16x32_bf16 v[184:187], v[152:155], v[92:95], v[184:187]
    ds_read_b64_tr_b16 v[150:151], v9 offset:22528
    v_mfma_f32_16x16x32_bf16 v[172:175], v[156:159], v[88:91], v[172:175]
    ds_read_b64_tr_b16 v[152:153], v10 offset:20480
    v_mfma_f32_16x16x32_bf16 v[188:191], v[156:159], v[92:95], v[188:191]
    ds_read_b64_tr_b16 v[154:155], v10 offset:22528
    buffer_load_dwordx4 v[88:91], v12, s[44:47], s82 offen offset:3072 sc1
    buffer_load_dwordx4 v[92:95], v12, s[52:55], s82 offen offset:3072 sc1
    s_and_b32 s82, s66, 15
    s_lshr_b64 s[66:67], s[66:67], 4
    s_lshl_b32 s82, s82, 12
    s_waitcnt vmcnt(14) lgkmcnt(10)
    v_mfma_f32_16x16x32_bf16 v[160:163], v[128:131], v[96:99], v[160:163]
    ds_read_b64_tr_b16 v[156:157], v11 offset:20480
    v_mfma_f32_16x16x32_bf16 v[176:179], v[128:131], v[100:103], v[176:179]
    ds_read_b64_tr_b16 v[158:159], v11 offset:22528
    v_mfma_f32_16x16x32_bf16 v[164:167], v[132:135], v[96:99], v[164:167]
    ds_read_b64_tr_b16 v[128:129], v8 offset:24576
    v_mfma_f32_16x16x32_bf16 v[180:183], v[132:135], v[100:103], v[180:183]
    ds_read_b64_tr_b16 v[130:131], v8 offset:26624
    s_waitcnt lgkmcnt(10)
    v_mfma_f32_16x16x32_bf16 v[168:171], v[136:139], v[96:99], v[168:171]
    ds_read_b64_tr_b16 v[132:133], v9 offset:24576
    v_mfma_f32_16x16x32_bf16 v[184:187], v[136:139], v[100:103], v[184:187]
    ds_read_b64_tr_b16 v[134:135], v9 offset:26624
    v_mfma_f32_16x16x32_bf16 v[172:175], v[140:143], v[96:99], v[172:175]
    ds_read_b64_tr_b16 v[136:137], v10 offset:24576
    v_mfma_f32_16x16x32_bf16 v[188:191], v[140:143], v[100:103], v[188:191]
    ds_read_b64_tr_b16 v[138:139], v10 offset:26624
    s_waitcnt vmcnt(12) lgkmcnt(10)
    v_mfma_f32_16x16x32_bf16 v[160:163], v[144:147], v[104:107], v[160:163]
    buffer_load_dwordx4 v[96:99], v12, s[44:47], s82 offen offset:0 sc1
    ds_read_b64_tr_b16 v[140:141], v11 offset:24576
    v_mfma_f32_16x16x32_bf16 v[176:179], v[144:147], v[108:111], v[176:179]
    buffer_load_dwordx4 v[100:103], v12, s[52:55], s82 offen offset:0 sc1
    ds_read_b64_tr_b16 v[142:143], v11 offset:26624
    v_mfma_f32_16x16x32_bf16 v[164:167], v[148:151], v[104:107], v[164:167]
    ds_read_b64_tr_b16 v[144:145], v8 offset:28672
    v_mfma_f32_16x16x32_bf16 v[180:183], v[148:151], v[108:111], v[180:183]
    ds_read_b64_tr_b16 v[146:147], v8 offset:30720
    s_waitcnt lgkmcnt(10)
    v_mfma_f32_16x16x32_bf16 v[168:171], v[152:155], v[104:107], v[168:171]
    ds_read_b64_tr_b16 v[148:149], v9 offset:28672
    v_mfma_f32_16x16x32_bf16 v[184:187], v[152:155], v[108:111], v[184:187]
    ds_read_b64_tr_b16 v[150:151], v9 offset:30720
    v_mfma_f32_16x16x32_bf16 v[172:175], v[156:159], v[104:107], v[172:175]
    ds_read_b64_tr_b16 v[152:153], v10 offset:28672
    v_mfma_f32_16x16x32_bf16 v[188:191], v[156:159], v[108:111], v[188:191]
    ds_read_b64_tr_b16 v[154:155], v10 offset:30720
    s_waitcnt vmcnt(12) lgkmcnt(10)
    v_mfma_f32_16x16x32_bf16 v[160:163], v[128:131], v[112:115], v[160:163]
    buffer_load_dwordx4 v[104:107], v12, s[44:47], s82 offen offset:1024 sc1
    ds_read_b64_tr_b16 v[156:157], v11 offset:28672
    v_mfma_f32_16x16x32_bf16 v[176:179], v[128:131], v[116:119], v[176:179]
    buffer_load_dwordx4 v[108:111], v12, s[52:55], s82 offen offset:1024 sc1
    ds_read_b64_tr_b16 v[158:159], v11 offset:30720
    s_barrier
    v_mfma_f32_16x16x32_bf16 v[164:167], v[132:135], v[112:115], v[164:167]
    ds_read_b64_tr_b16 v[128:129], v8 offset:32768
    v_mfma_f32_16x16x32_bf16 v[180:183], v[132:135], v[116:119], v[180:183]
    ds_read_b64_tr_b16 v[130:131], v8 offset:34816
    s_waitcnt lgkmcnt(10)
    v_mfma_f32_16x16x32_bf16 v[168:171], v[136:139], v[112:115], v[168:171]
    ds_read_b64_tr_b16 v[132:133], v9 offset:32768
    v_mfma_f32_16x16x32_bf16 v[184:187], v[136:139], v[116:119], v[184:187]
    ds_read_b64_tr_b16 v[134:135], v9 offset:34816
    v_mfma_f32_16x16x32_bf16 v[172:175], v[140:143], v[112:115], v[172:175]
    ds_read_b64_tr_b16 v[136:137], v10 offset:32768
    v_mfma_f32_16x16x32_bf16 v[188:191], v[140:143], v[116:119], v[188:191]
    ds_read_b64_tr_b16 v[138:139], v10 offset:34816
    s_waitcnt vmcnt(12) lgkmcnt(10)
    v_mfma_f32_16x16x32_bf16 v[160:163], v[144:147], v[120:123], v[160:163]
    buffer_load_dwordx4 v[112:115], v12, s[44:47], s82 offen offset:2048 sc1
    ds_read_b64_tr_b16 v[140:141], v11 offset:32768
    v_mfma_f32_16x16x32_bf16 v[176:179], v[144:147], v[124:127], v[176:179]
    buffer_load_dwordx4 v[116:119], v12, s[52:55], s82 offen offset:2048 sc1
    ds_read_b64_tr_b16 v[142:143], v11 offset:34816
    v_mfma_f32_16x16x32_bf16 v[164:167], v[148:151], v[120:123], v[164:167]
    ds_read_b64_tr_b16 v[144:145], v8 offset:36864
    v_mfma_f32_16x16x32_bf16 v[180:183], v[148:151], v[124:127], v[180:183]
    ds_read_b64_tr_b16 v[146:147], v8 offset:38912
    s_waitcnt lgkmcnt(10)
    v_mfma_f32_16x16x32_bf16 v[168:171], v[152:155], v[120:123], v[168:171]
    ds_read_b64_tr_b16 v[148:149], v9 offset:36864
    v_mfma_f32_16x16x32_bf16 v[184:187], v[152:155], v[124:127], v[184:187]
    ds_read_b64_tr_b16 v[150:151], v9 offset:38912
    v_mfma_f32_16x16x32_bf16 v[172:175], v[156:159], v[120:123], v[172:175]
    ds_read_b64_tr_b16 v[152:153], v10 offset:36864
    v_mfma_f32_16x16x32_bf16 v[188:191], v[156:159], v[124:127], v[188:191]
    ds_read_b64_tr_b16 v[154:155], v10 offset:38912
    buffer_load_dwordx4 v[120:123], v12, s[44:47], s82 offen offset:3072 sc1
    buffer_load_dwordx4 v[124:127], v12, s[52:55], s82 offen offset:3072 sc1
    s_and_b32 s82, s66, 15
    s_lshr_b64 s[66:67], s[66:67], 4
    s_lshl_b32 s82, s82, 12
    s_cmp_ge_u32 s81, 3
    s_cselect_b32 s82, 0x10000, s82
    s_waitcnt vmcnt(14) lgkmcnt(10)
    v_mfma_f32_16x16x32_bf16 v[160:163], v[128:131], v[64:67], v[160:163]
    ds_read_b64_tr_b16 v[156:157], v11 offset:36864
    v_mfma_f32_16x16x32_bf16 v[176:179], v[128:131], v[68:71], v[176:179]
    ds_read_b64_tr_b16 v[158:159], v11 offset:38912
    v_mfma_f32_16x16x32_bf16 v[164:167], v[132:135], v[64:67], v[164:167]
    ds_read_b64_tr_b16 v[128:129], v8 offset:40960
    v_mfma_f32_16x16x32_bf16 v[180:183], v[132:135], v[68:71], v[180:183]
    ds_read_b64_tr_b16 v[130:131], v8 offset:43008
    s_waitcnt lgkmcnt(10)
    v_mfma_f32_16x16x32_bf16 v[168:171], v[136:139], v[64:67], v[168:171]
    ds_read_b64_tr_b16 v[132:133], v9 offset:40960
    v_mfma_f32_16x16x32_bf16 v[184:187], v[136:139], v[68:71], v[184:187]
    ds_read_b64_tr_b16 v[134:135], v9 offset:43008
    v_mfma_f32_16x16x32_bf16 v[172:175], v[140:143], v[64:67], v[172:175]
    ds_read_b64_tr_b16 v[136:137], v10 offset:40960
    v_mfma_f32_16x16x32_bf16 v[188:191], v[140:143], v[68:71], v[188:191]
    ds_read_b64_tr_b16 v[138:139], v10 offset:43008
    s_waitcnt vmcnt(12) lgkmcnt(10)
    v_mfma_f32_16x16x32_bf16 v[160:163], v[144:147], v[72:75], v[160:163]
    buffer_load_dwordx4 v[64:67], v12, s[44:47], s82 offen offset:0 sc1
    ds_read_b64_tr_b16 v[140:141], v11 offset:40960
    v_mfma_f32_16x16x32_bf16 v[176:179], v[144:147], v[76:79], v[176:179]
    buffer_load_dwordx4 v[68:71], v12, s[52:55], s82 offen offset:0 sc1
    ds_read_b64_tr_b16 v[142:143], v11 offset:43008
    v_mfma_f32_16x16x32_bf16 v[164:167], v[148:151], v[72:75], v[164:167]
    ds_read_b64_tr_b16 v[144:145], v8 offset:45056
    v_mfma_f32_16x16x32_bf16 v[180:183], v[148:151], v[76:79], v[180:183]
    ds_read_b64_tr_b16 v[146:147], v8 offset:47104
    s_waitcnt lgkmcnt(10)
    v_mfma_f32_16x16x32_bf16 v[168:171], v[152:155], v[72:75], v[168:171]
    ds_read_b64_tr_b16 v[148:149], v9 offset:45056
    v_mfma_f32_16x16x32_bf16 v[184:187], v[152:155], v[76:79], v[184:187]
    ds_read_b64_tr_b16 v[150:151], v9 offset:47104
    v_mfma_f32_16x16x32_bf16 v[172:175], v[156:159], v[72:75], v[172:175]
    ds_read_b64_tr_b16 v[152:153], v10 offset:45056
    v_mfma_f32_16x16x32_bf16 v[188:191], v[156:159], v[76:79], v[188:191]
    ds_read_b64_tr_b16 v[154:155], v10 offset:47104
    s_waitcnt vmcnt(12) lgkmcnt(10)
    v_mfma_f32_16x16x32_bf16 v[160:163], v[128:131], v[80:83], v[160:163]
    buffer_load_dwordx4 v[72:75], v12, s[44:47], s82 offen offset:1024 sc1
    ds_read_b64_tr_b16 v[156:157], v11 offset:45056
    v_mfma_f32_16x16x32_bf16 v[176:179], v[128:131], v[84:87], v[176:179]
    buffer_load_dwordx4 v[76:79], v12, s[52:55], s82 offen offset:1024 sc1
    ds_read_b64_tr_b16 v[158:159], v11 offset:47104
    s_barrier
    v_mfma_f32_16x16x32_bf16 v[164:167], v[132:135], v[80:83], v[164:167]
    ds_read_b64_tr_b16 v[128:129], v8 offset:49152
    v_mfma_f32_16x16x32_bf16 v[180:183], v[132:135], v[84:87], v[180:183]
    ds_read_b64_tr_b16 v[130:131], v8 offset:51200
    s_waitcnt lgkmcnt(10)
    v_mfma_f32_16x16x32_bf16 v[168:171], v[136:139], v[80:83], v[168:171]
    ds_read_b64_tr_b16 v[132:133], v9 offset:49152
    v_mfma_f32_16x16x32_bf16 v[184:187], v[136:139], v[84:87], v[184:187]
    ds_read_b64_tr_b16 v[134:135], v9 offset:51200
    v_mfma_f32_16x16x32_bf16 v[172:175], v[140:143], v[80:83], v[172:175]
    ds_read_b64_tr_b16 v[136:137], v10 offset:49152
    v_mfma_f32_16x16x32_bf16 v[188:191], v[140:143], v[84:87], v[188:191]
    ds_read_b64_tr_b16 v[138:139], v10 offset:51200
    s_waitcnt vmcnt(12) lgkmcnt(10)
    v_mfma_f32_16x16x32_bf16 v[160:163], v[144:147], v[88:91], v[160:163]
    buffer_load_dwordx4 v[80:83], v12, s[44:47], s82 offen offset:2048 sc1
    ds_read_b64_tr_b16 v[140:141], v11 offset:49152
    v_mfma_f32_16x16x32_bf16 v[176:179], v[144:147], v[92:95], v[176:179]
    buffer_load_dwordx4 v[84:87], v12, s[52:55], s82 offen offset:2048 sc1
    ds_read_b64_tr_b16 v[142:143], v11 offset:51200
    v_mfma_f32_16x16x32_bf16 v[164:167], v[148:151], v[88:91], v[164:167]
    ds_read_b64_tr_b16 v[144:145], v8 offset:53248
    v_mfma_f32_16x16x32_bf16 v[180:183], v[148:151], v[92:95], v[180:183]
    ds_read_b64_tr_b16 v[146:147], v8 offset:55296
    s_waitcnt lgkmcnt(10)
    v_mfma_f32_16x16x32_bf16 v[168:171], v[152:155], v[88:91], v[168:171]
    ds_read_b64_tr_b16 v[148:149], v9 offset:53248
    v_mfma_f32_16x16x32_bf16 v[184:187], v[152:155], v[92:95], v[184:187]
    ds_read_b64_tr_b16 v[150:151], v9 offset:55296
    v_mfma_f32_16x16x32_bf16 v[172:175], v[156:159], v[88:91], v[172:175]
    ds_read_b64_tr_b16 v[152:153], v10 offset:53248
    v_mfma_f32_16x16x32_bf16 v[188:191], v[156:159], v[92:95], v[188:191]
    ds_read_b64_tr_b16 v[154:155], v10 offset:55296
    buffer_load_dwordx4 v[88:91], v12, s[44:47], s82 offen offset:3072 sc1
    buffer_load_dwordx4 v[92:95], v12, s[52:55], s82 offen offset:3072 sc1
    s_and_b32 s82, s66, 15
    s_lshr_b64 s[66:67], s[66:67], 4
    s_lshl_b32 s82, s82, 12
    s_cmp_ge_u32 s81, 3
    s_cselect_b32 s82, 0x10000, s82
    s_waitcnt vmcnt(14) lgkmcnt(10)
    v_mfma_f32_16x16x32_bf16 v[160:163], v[128:131], v[96:99], v[160:163]
    ds_read_b64_tr_b16 v[156:157], v11 offset:53248
    v_mfma_f32_16x16x32_bf16 v[176:179], v[128:131], v[100:103], v[176:179]
    ds_read_b64_tr_b16 v[158:159], v11 offset:55296
    v_mfma_f32_16x16x32_bf16 v[164:167], v[132:135], v[96:99], v[164:167]
    ds_read_b64_tr_b16 v[128:129], v8 offset:57344
    v_mfma_f32_16x16x32_bf16 v[180:183], v[132:135], v[100:103], v[180:183]
    ds_read_b64_tr_b16 v[130:131], v8 offset:59392
    s_waitcnt lgkmcnt(10)
    v_mfma_f32_16x16x32_bf16 v[168:171], v[136:139], v[96:99], v[168:171]
    ds_read_b64_tr_b16 v[132:133], v9 offset:57344
    v_mfma_f32_16x16x32_bf16 v[184:187], v[136:139], v[100:103], v[184:187]
    ds_read_b64_tr_b16 v[134:135], v9 offset:59392
    v_mfma_f32_16x16x32_bf16 v[172:175], v[140:143], v[96:99], v[172:175]
    ds_read_b64_tr_b16 v[136:137], v10 offset:57344
    v_mfma_f32_16x16x32_bf16 v[188:191], v[140:143], v[100:103], v[188:191]
    ds_read_b64_tr_b16 v[138:139], v10 offset:59392
    s_waitcnt vmcnt(12) lgkmcnt(10)
    v_mfma_f32_16x16x32_bf16 v[160:163], v[144:147], v[104:107], v[160:163]
    buffer_load_dwordx4 v[96:99], v12, s[44:47], s82 offen offset:0 sc1
    ds_read_b64_tr_b16 v[140:141], v11 offset:57344
    v_mfma_f32_16x16x32_bf16 v[176:179], v[144:147], v[108:111], v[176:179]
    buffer_load_dwordx4 v[100:103], v12, s[52:55], s82 offen offset:0 sc1
    ds_read_b64_tr_b16 v[142:143], v11 offset:59392
    v_mfma_f32_16x16x32_bf16 v[164:167], v[148:151], v[104:107], v[164:167]
    ds_read_b64_tr_b16 v[144:145], v8 offset:61440
    v_mfma_f32_16x16x32_bf16 v[180:183], v[148:151], v[108:111], v[180:183]
    ds_read_b64_tr_b16 v[146:147], v8 offset:63488
    s_waitcnt lgkmcnt(10)
    v_mfma_f32_16x16x32_bf16 v[168:171], v[152:155], v[104:107], v[168:171]
    ds_read_b64_tr_b16 v[148:149], v9 offset:61440
    v_mfma_f32_16x16x32_bf16 v[184:187], v[152:155], v[108:111], v[184:187]
    ds_read_b64_tr_b16 v[150:151], v9 offset:63488
    v_mfma_f32_16x16x32_bf16 v[172:175], v[156:159], v[104:107], v[172:175]
    ds_read_b64_tr_b16 v[152:153], v10 offset:61440
    v_mfma_f32_16x16x32_bf16 v[188:191], v[156:159], v[108:111], v[188:191]
    ds_read_b64_tr_b16 v[154:155], v10 offset:63488
    s_waitcnt vmcnt(12) lgkmcnt(10)
    v_mfma_f32_16x16x32_bf16 v[160:163], v[128:131], v[112:115], v[160:163]
    buffer_load_dwordx4 v[104:107], v12, s[44:47], s82 offen offset:1024 sc1
    ds_read_b64_tr_b16 v[156:157], v11 offset:61440
    v_mfma_f32_16x16x32_bf16 v[176:179], v[128:131], v[116:119], v[176:179]
    buffer_load_dwordx4 v[108:111], v12, s[52:55], s82 offen offset:1024 sc1
    ds_read_b64_tr_b16 v[158:159], v11 offset:63488
    s_barrier
    v_xor_b32 v8, 0x10000, v8
    v_xor_b32 v9, 0x10000, v9
    v_xor_b32 v10, 0x10000, v10
    v_xor_b32 v11, 0x10000, v11
    v_mfma_f32_16x16x32_bf16 v[164:167], v[132:135], v[112:115], v[164:167]
    ds_read_b64_tr_b16 v[128:129], v8 offset:0
    v_mfma_f32_16x16x32_bf16 v[180:183], v[132:135], v[116:119], v[180:183]
    ds_read_b64_tr_b16 v[130:131], v8 offset:2048
    s_waitcnt lgkmcnt(10)
    v_mfma_f32_16x16x32_bf16 v[168:171], v[136:139], v[112:115], v[168:171]
    ds_read_b64_tr_b16 v[132:133], v9 offset:0
    v_mfma_f32_16x16x32_bf16 v[184:187], v[136:139], v[116:119], v[184:187]
    ds_read_b64_tr_b16 v[134:135], v9 offset:2048
    v_mfma_f32_16x16x32_bf16 v[172:175], v[140:143], v[112:115], v[172:175]
    ds_read_b64_tr_b16 v[136:137], v10 offset:0
    v_mfma_f32_16x16x32_bf16 v[188:191], v[140:143], v[116:119], v[188:191]
    ds_read_b64_tr_b16 v[138:139], v10 offset:2048
    s_waitcnt vmcnt(12) lgkmcnt(10)
    v_mfma_f32_16x16x32_bf16 v[160:163], v[144:147], v[120:123], v[160:163]
    buffer_load_dwordx4 v[112:115], v12, s[44:47], s82 offen offset:2048 sc1
    ds_read_b64_tr_b16 v[140:141], v11 offset:0
    v_mfma_f32_16x16x32_bf16 v[176:179], v[144:147], v[124:127], v[176:179]
    buffer_load_dwordx4 v[116:119], v12, s[52:55], s82 offen offset:2048 sc1
    ds_read_b64_tr_b16 v[142:143], v11 offset:2048
    v_mfma_f32_16x16x32_bf16 v[164:167], v[148:151], v[120:123], v[164:167]
    ds_read_b64_tr_b16 v[144:145], v8 offset:4096
    v_mfma_f32_16x16x32_bf16 v[180:183], v[148:151], v[124:127], v[180:183]
    ds_read_b64_tr_b16 v[146:147], v8 offset:6144
    s_waitcnt lgkmcnt(10)
    v_mfma_f32_16x16x32_bf16 v[168:171], v[152:155], v[120:123], v[168:171]
    ds_read_b64_tr_b16 v[148:149], v9 offset:4096
    v_mfma_f32_16x16x32_bf16 v[184:187], v[152:155], v[124:127], v[184:187]
    ds_read_b64_tr_b16 v[150:151], v9 offset:6144
    v_mfma_f32_16x16x32_bf16 v[172:175], v[156:159], v[120:123], v[172:175]
    ds_read_b64_tr_b16 v[152:153], v10 offset:4096
    v_mfma_f32_16x16x32_bf16 v[188:191], v[156:159], v[124:127], v[188:191]
    ds_read_b64_tr_b16 v[154:155], v10 offset:6144
    buffer_load_dwordx4 v[120:123], v12, s[44:47], s82 offen offset:3072 sc1
    buffer_load_dwordx4 v[124:127], v12, s[52:55], s82 offen offset:3072 sc1
    s_and_b32 s82, s66, 15
    s_lshr_b64 s[66:67], s[66:67], 4
    s_lshl_b32 s82, s82, 12
    s_cmp_ge_u32 s81, 3
    s_cselect_b32 s82, 0x10000, s82
    s_add_u32 s81, s81, 1
    s_cmp_lt_u32 s81, 4
    s_cbranch_scc1 L_B_loop
    s_waitcnt lgkmcnt(0)
    s_nop 4
    v_pk_mul_f32 v[48:49], v[160:161], v[160:161]
    v_pk_mul_f32 v[50:51], v[162:163], v[162:163]
    v_pk_mul_f32 v[52:53], v[164:165], v[164:165]
    v_pk_mul_f32 v[54:55], v[166:167], v[166:167]
    v_pk_fma_f32 v[48:49], v[48:49], s[90:91], v[44:45]
    v_pk_fma_f32 v[50:51], v[50:51], s[90:91], v[44:45]
    v_pk_fma_f32 v[52:53], v[52:53], s[90:91], v[44:45]
    v_pk_fma_f32 v[54:55], v[54:55], s[90:91], v[44:45]
    v_pk_mul_f32 v[48:49], v[48:49], v[160:161]
    v_pk_mul_f32 v[50:51], v[50:51], v[162:163]
    v_pk_mul_f32 v[52:53], v[52:53], v[164:165]
    v_pk_mul_f32 v[54:55], v[54:55], v[166:167]
    v_exp_f32 v48, v48
    v_exp_f32 v49, v49
    v_exp_f32 v50, v50
    v_exp_f32 v51, v51
    v_exp_f32 v52, v52
    v_exp_f32 v53, v53
    v_exp_f32 v54, v54
    v_exp_f32 v55, v55
    v_pk_add_f32 v[48:49], v[48:49], v[46:47]
    v_pk_add_f32 v[50:51], v[50:51], v[46:47]
    v_pk_add_f32 v[52:53], v[52:53], v[46:47]
    v_pk_add_f32 v[54:55], v[54:55], v[46:47]
    v_rcp_f32 v48, v48
    v_rcp_f32 v49, v49
    v_rcp_f32 v50, v50
    v_rcp_f32 v51, v51
    v_rcp_f32 v52, v52
    v_rcp_f32 v53, v53
    v_rcp_f32 v54, v54
    v_rcp_f32 v55, v55
    v_pk_mul_f32 v[160:161], v[160:161], v[48:49]
    v_pk_mul_f32 v[162:163], v[162:163], v[50:51]
    v_pk_mul_f32 v[164:165], v[164:165], v[52:53]
    v_pk_mul_f32 v[166:167], v[166:167], v[54:55]
    v_cvt_pk_bf16_f32 v56, v160, v161
    v_cvt_pk_bf16_f32 v57, v162, v163
    v_cvt_pk_bf16_f32 v58, v164, v165
    v_cvt_pk_bf16_f32 v59, v166, v167
    buffer_store_dwordx4 v[56:59], v12, s[32:35], s92 offen offset:0 sc1
    v_pk_mul_f32 v[48:49], v[168:169], v[168:169]
    v_pk_mul_f32 v[50:51], v[170:171], v[170:171]
    v_pk_mul_f32 v[52:53], v[172:173], v[172:173]
    v_pk_mul_f32 v[54:55], v[174:175], v[174:175]
    v_pk_fma_f32 v[48:49], v[48:49], s[90:91], v[44:45]
    v_pk_fma_f32 v[50:51], v[50:51], s[90:91], v[44:45]
    v_pk_fma_f32 v[52:53], v[52:53], s[90:91], v[44:45]
    v_pk_fma_f32 v[54:55], v[54:55], s[90:91], v[44:45]
    v_pk_mul_f32 v[48:49], v[48:49], v[168:169]
    v_pk_mul_f32 v[50:51], v[50:51], v[170:171]
    v_pk_mul_f32 v[52:53], v[52:53], v[172:173]
    v_pk_mul_f32 v[54:55], v[54:55], v[174:175]
    v_exp_f32 v48, v48
    v_exp_f32 v49, v49
    v_exp_f32 v50, v50
    v_exp_f32 v51, v51
    v_exp_f32 v52, v52
    v_exp_f32 v53, v53
    v_exp_f32 v54, v54
    v_exp_f32 v55, v55
    v_pk_add_f32 v[48:49], v[48:49], v[46:47]
    v_pk_add_f32 v[50:51], v[50:51], v[46:47]
    v_pk_add_f32 v[52:53], v[52:53], v[46:47]
    v_pk_add_f32 v[54:55], v[54:55], v[46:47]
    v_rcp_f32 v48, v48
    v_rcp_f32 v49, v49
    v_rcp_f32 v50, v50
    v_rcp_f32 v51, v51
    v_rcp_f32 v52, v52
    v_rcp_f32 v53, v53
    v_rcp_f32 v54, v54
    v_rcp_f32 v55, v55
    v_pk_mul_f32 v[168:169], v[168:169], v[48:49]
    v_pk_mul_f32 v[170:171], v[170:171], v[50:51]
    v_pk_mul_f32 v[172:173], v[172:173], v[52:53]
    v_pk_mul_f32 v[174:175], v[174:175], v[54:55]
    v_cvt_pk_bf16_f32 v60, v168, v169
    v_cvt_pk_bf16_f32 v61, v170, v171
    v_cvt_pk_bf16_f32 v62, v172, v173
    v_cvt_pk_bf16_f32 v63, v174, v175
    buffer_store_dwordx4 v[60:63], v12, s[32:35], s92 offen offset:1024 sc1
    s_add_u32 s92, s92, 69632
    v_pk_mul_f32 v[48:49], v[176:177], v[176:177]
    v_pk_mul_f32 v[50:51], v[178:179], v[178:179]
    v_pk_mul_f32 v[52:53], v[180:181], v[180:181]
    v_pk_mul_f32 v[54:55], v[182:183], v[182:183]
    v_pk_fma_f32 v[48:49], v[48:49], s[90:91], v[44:45]
    v_pk_fma_f32 v[50:51], v[50:51], s[90:91], v[44:45]
    v_pk_fma_f32 v[52:53], v[52:53], s[90:91], v[44:45]
    v_pk_fma_f32 v[54:55], v[54:55], s[90:91], v[44:45]
    v_pk_mul_f32 v[48:49], v[48:49], v[176:177]
    v_pk_mul_f32 v[50:51], v[50:51], v[178:179]
    v_pk_mul_f32 v[52:53], v[52:53], v[180:181]
    v_pk_mul_f32 v[54:55], v[54:55], v[182:183]
    v_exp_f32 v48, v48
    v_exp_f32 v49, v49
    v_exp_f32 v50, v50
    v_exp_f32 v51, v51
    v_exp_f32 v52, v52
    v_exp_f32 v53, v53
    v_exp_f32 v54, v54
    v_exp_f32 v55, v55
    v_pk_add_f32 v[48:49], v[48:49], v[46:47]
    v_pk_add_f32 v[50:51], v[50:51], v[46:47]
    v_pk_add_f32 v[52:53], v[52:53], v[46:47]
    v_pk_add_f32 v[54:55], v[54:55], v[46:47]
    v_rcp_f32 v48, v48
    v_rcp_f32 v49, v49
    v_rcp_f32 v50, v50
    v_rcp_f32 v51, v51
    v_rcp_f32 v52, v52
    v_rcp_f32 v53, v53
    v_rcp_f32 v54, v54
    v_rcp_f32 v55, v55
    v_pk_mul_f32 v[176:177], v[176:177], v[48:49]
    v_pk_mul_f32 v[178:179], v[178:179], v[50:51]
    v_pk_mul_f32 v[180:181], v[180:181], v[52:53]
    v_pk_mul_f32 v[182:183], v[182:183], v[54:55]
    v_cvt_pk_bf16_f32 v56, v176, v177
    v_cvt_pk_bf16_f32 v57, v178, v179
    v_cvt_pk_bf16_f32 v58, v180, v181
    v_cvt_pk_bf16_f32 v59, v182, v183
    buffer_store_dwordx4 v[56:59], v12, s[32:35], s92 offen offset:0 sc1
    v_pk_mul_f32 v[48:49], v[184:185], v[184:185]
    v_pk_mul_f32 v[50:51], v[186:187], v[186:187]
    v_pk_mul_f32 v[52:53], v[188:189], v[188:189]
    v_pk_mul_f32 v[54:55], v[190:191], v[190:191]
    v_pk_fma_f32 v[48:49], v[48:49], s[90:91], v[44:45]
    v_pk_fma_f32 v[50:51], v[50:51], s[90:91], v[44:45]
    v_pk_fma_f32 v[52:53], v[52:53], s[90:91], v[44:45]
    v_pk_fma_f32 v[54:55], v[54:55], s[90:91], v[44:45]
    v_pk_mul_f32 v[48:49], v[48:49], v[184:185]
    v_pk_mul_f32 v[50:51], v[50:51], v[186:187]
    v_pk_mul_f32 v[52:53], v[52:53], v[188:189]
    v_pk_mul_f32 v[54:55], v[54:55], v[190:191]
    v_exp_f32 v48, v48
    v_exp_f32 v49, v49
    v_exp_f32 v50, v50
    v_exp_f32 v51, v51
    v_exp_f32 v52, v52
    v_exp_f32 v53, v53
    v_exp_f32 v54, v54
    v_exp_f32 v55, v55
    v_pk_add_f32 v[48:49], v[48:49], v[46:47]
    v_pk_add_f32 v[50:51], v[50:51], v[46:47]
    v_pk_add_f32 v[52:53], v[52:53], v[46:47]
    v_pk_add_f32 v[54:55], v[54:55], v[46:47]
    v_rcp_f32 v48, v48
    v_rcp_f32 v49, v49
    v_rcp_f32 v50, v50
    v_rcp_f32 v51, v51
    v_rcp_f32 v52, v52
    v_rcp_f32 v53, v53
    v_rcp_f32 v54, v54
    v_rcp_f32 v55, v55
    v_pk_mul_f32 v[184:185], v[184:185], v[48:49]
    v_pk_mul_f32 v[186:187], v[186:187], v[50:51]
    v_pk_mul_f32 v[188:189], v[188:189], v[52:53]
    v_pk_mul_f32 v[190:191], v[190:191], v[54:55]
    v_cvt_pk_bf16_f32 v60, v184, v185
    v_cvt_pk_bf16_f32 v61, v186, v187
    v_cvt_pk_bf16_f32 v62, v188, v189
    v_cvt_pk_bf16_f32 v63, v190, v191
    buffer_store_dwordx4 v[60:63], v12, s[32:35], s92 offen offset:1024 sc1
    s_waitcnt vmcnt(0)
    s_barrier
    s_branch L_F_comp
L_B_aux:
    s_barrier
    s_waitcnt vmcnt(20)
    s_barrier
    s_cmp_lg_u32 s29, 7
    s_cbranch_scc1 L_B_nop1
    v_mul_u32_u24 v2, 128, v1
    v_add_u32 v2, 4096, v2
    buffer_load_dword v3, v2, s[32:35], 0 offen sc1
L_B_nop1:
    s_waitcnt vmcnt(16)
    s_barrier
    s_cmp_lg_u32 s29, 7
    s_cbranch_scc1 L_B_nop2
    s_waitcnt vmcnt(0)
    v_cmp_ne_u32 vcc, s28, v3
    s_nop 1
    s_cmp_eq_u64 vcc, 0
    s_cbranch_scc1 L_B_nop2
    s_mov_b32 s78, 0
Lpoll_10:
    buffer_load_dword v4, v2, s[32:35], 0 offen sc1
    s_waitcnt vmcnt(0)
    v_cmp_ne_u32 vcc, s28, v4
    s_nop 1
    s_cmp_eq_u64 vcc, 0
    s_cbranch_scc1 Lpdone_11
    s_add_u32 s78, s78, 1
    s_cmp_lt_u32 s78, 131072
    s_cbranch_scc0 Lpdone_11
    s_sleep 1
    s_branch Lpoll_10
Lpdone_11:
L_B_nop2:
    s_waitcnt vmcnt(12)
    s_barrier
    s_and_b32 s81, s81, 0x1ffff
    s_and_b32 s82, s66, 15
    s_lshr_b64 s[66:67], s[66:67], 4
    s_mul_i32 s82, s82, 393216
    s_add_u32 s82, s82, s80
    s_mov_b32 m0, s81
    s_nop 0
    buffer_load_dwordx4 v8, s[40:43], s82 offen offset:0 lds
    buffer_load_dwordx4 v9, s[40:43], s82 offen offset:1024 lds
    s_waitcnt vmcnt(10)
    s_barrier
    s_mov_b32 m0, s81
    s_nop 0
    buffer_load_dwordx4 v10, s[40:43], s82 offen offset:2048 lds
    buffer_load_dwordx4 v11, s[40:43], s82 offen offset:3072 lds
    s_add_u32 s81, s81, 16384
    s_and_b32 s82, s66, 15
    s_lshr_b64 s[66:67], s[66:67], 4
    s_mul_i32 s82, s82, 393216
    s_add_u32 s82, s82, s80
    s_mov_b32 m0, s81
    s_nop 0
    buffer_load_dwordx4 v8, s[40:43], s82 offen offset:0 lds
    s_waitcnt vmcnt(9)
    s_barrier
    s_mov_b32 m0, s81
    s_nop 0
    buffer_load_dwordx4 v9, s[40:43], s82 offen offset:1024 lds
    buffer_load_dwordx4 v10, s[40:43], s82 offen offset:2048 lds
    buffer_load_dwordx4 v11, s[40:43], s82 offen offset:3072 lds
    s_add_u32 s81, s81, 16384
    s_waitcnt vmcnt(8)
    s_barrier
    s_and_b32 s82, s66, 15
    s_lshr_b64 s[66:67], s[66:67], 4
    s_mul_i32 s82, s82, 393216
    s_add_u32 s82, s82, s80
    s_mov_b32 m0, s81
    s_nop 0
    buffer_load_dwordx4 v8, s[40:43], s82 offen offset:0 lds
    buffer_load_dwordx4 v9, s[40:43], s82 offen offset:1024 lds
    s_waitcnt vmcnt(6)
    s_barrier
    s_cmp_lg_u32 s29, 7
    s_cbranch_scc1 Lnct_12
    s_getpc_b64 s[60:61]
Lpc_13:
    v_lshlrev_b32 v24, 7, v1
    s_add_u32 s62, s60, L_F_comp-Lpc_13+0
    s_addc_u32 s63, s61, 0
    v_min_u32 v25, L_exit-L_F_comp-0, v24
    global_load_dword v253, v25, s[62:63]
    s_add_u32 s62, s60, L_F_comp-Lpc_13+8192
    s_addc_u32 s63, s61, 0
    v_min_u32 v25, L_exit-L_F_comp-8192, v24
    global_load_dword v253, v25, s[62:63]
Lnct_12:
    s_mov_b32 m0, s81
    s_nop 0
    buffer_load_dwordx4 v10, s[40:43], s82 offen offset:2048 lds
    buffer_load_dwordx4 v11, s[40:43], s82 offen offset:3072 lds
    s_add_u32 s81, s81, 16384
    s_and_b32 s82, s66, 15
    s_lshr_b64 s[66:67], s[66:67], 4
    s_mul_i32 s82, s82, 393216
    s_add_u32 s82, s82, s80
    s_mov_b32 m0, s81
    s_nop 0
    buffer_load_dwordx4 v8, s[40:43], s82 offen offset:0 lds
    s_waitcnt vmcnt(5)
    s_barrier
    s_mov_b32 m0, s81
    s_nop 0
    buffer_load_dwordx4 v9, s[40:43], s82 offen offset:1024 lds
    buffer_load_dwordx4 v10, s[40:43], s82 offen offset:2048 lds
    buffer_load_dwordx4 v11, s[40:43], s82 offen offset:3072 lds
    s_add_u32 s81, s81, 16384
    s_waitcnt vmcnt(12)
    s_barrier
    s_and_b32 s82, s66, 15
    s_lshr_b64 s[66:67], s[66:67], 4
    s_mul_i32 s82, s82, 393216
    s_add_u32 s82, s82, s80
    s_mov_b32 m0, s81
    s_nop 0
    buffer_load_dwordx4 v8, s[40:43], s82 offen offset:0 lds
    buffer_load_dwordx4 v9, s[40:43], s82 offen offset:1024 lds
    s_waitcnt vmcnt(10)
    s_barrier
    s_mov_b32 m0, s81
    s_nop 0
    buffer_load_dwordx4 v10, s[40:43], s82 offen offset:2048 lds
    buffer_load_dwordx4 v11, s[40:43], s82 offen offset:3072 lds
    s_add_u32 s81, s81, 16384
    s_and_b32 s82, s66, 15
    s_lshr_b64 s[66:67], s[66:67], 4
    s_mul_i32 s82, s82, 393216
    s_add_u32 s82, s82, s80
    s_mov_b32 m0, s81
    s_nop 0
    buffer_load_dwordx4 v8, s[40:43], s82 offen offset:0 lds
    s_waitcnt vmcnt(9)
    s_barrier
    s_mov_b32 m0, s81
    s_nop 0
    buffer_load_dwordx4 v9, s[40:43], s82 offen offset:1024 lds
    buffer_load_dwordx4 v10, s[40:43], s82 offen offset:2048 lds
    buffer_load_dwordx4 v11, s[40:43], s82 offen offset:3072 lds
    s_add_u32 s81, s81, 16384
    s_waitcnt vmcnt(8)
    s_barrier
    s_and_b32 s82, s66, 15
    s_lshr_b64 s[66:67], s[66:67], 4
    s_mul_i32 s82, s82, 393216
    s_add_u32 s82, s82, s80
    s_mov_b32 m0, s81
    s_nop 0
    buffer_load_dwordx4 v8, s[40:43], s82 offen offset:0 lds
    buffer_load_dwordx4 v9, s[40:43], s82 offen offset:1024 lds
    s_waitcnt vmcnt(6)
    s_barrier
    s_mov_b32 m0, s81
    s_nop 0
    buffer_load_dwordx4 v10, s[40:43], s82 offen offset:2048 lds
    buffer_load_dwordx4 v11, s[40:43], s82 offen offset:3072 lds
    s_add_u32 s81, s81, 16384
    s_and_b32 s82, s66, 15
    s_lshr_b64 s[66:67], s[66:67], 4
    s_mul_i32 s82, s82, 393216
    s_add_u32 s82, s82, s80
    s_mov_b32 m0, s81
    s_nop 0
    buffer_load_dwordx4 v8, s[40:43], s82 offen offset:0 lds
    s_waitcnt vmcnt(5)
    s_barrier
    s_mov_b32 m0, s81
    s_nop 0
    buffer_load_dwordx4 v9, s[40:43], s82 offen offset:1024 lds
    buffer_load_dwordx4 v10, s[40:43], s82 offen offset:2048 lds
    buffer_load_dwordx4 v11, s[40:43], s82 offen offset:3072 lds
    s_add_u32 s81, s81, 16384
    s_waitcnt vmcnt(4)
    s_barrier
    s_waitcnt vmcnt(0)
    s_barrier
    s_lshl_b32 s79, s77, 1
    s_add_u32 s79, s79, s76
    s_and_b32 s79, s79, 7
    s_mov_b32 s66, 0x76543210
    s_mov_b32 s67, 0xba98
    s_cmp_eq_u32 s79, 0
    s_cselect_b32 s66, 0x76543102, s66
    s_cselect_b32 s67, 0xb98a, s67
    s_cmp_eq_u32 s79, 1
    s_cselect_b32 s66, 0x76542130, s66
    s_cselect_b32 s67, 0xa9b8, s67
    s_cmp_eq_u32 s79, 2
    s_cselect_b32 s66, 0x76532410, s66
    s_cselect_b32 s67, 0xba98, s67
    s_cmp_eq_u32 s79, 3
    s_cselect_b32 s66, 0x76435210, s66
    s_cselect_b32 s67, 0xba98, s67
    s_cmp_eq_u32 s79, 4
    s_cselect_b32 s66, 0x75463210, s66
    s_cselect_b32 s67, 0xba98, s67
    s_cmp_eq_u32 s79, 5
    s_cselect_b32 s66, 0x65743210, s66
    s_cselect_b32 s67, 0xba98, s67
    s_cmp_eq_u32 s79, 6
    s_cselect_b32 s66, 0x68543210, s66
    s_cselect_b32 s67, 0xba97, s67
    s_cmp_eq_u32 s79, 7
    s_cselect_b32 s66, 0x96543210, s66
    s_cselect_b32 s67, 0xba87, s67
    v_lshrrev_b32 v240, 3, v1
    v_lshrrev_b32 v241, 4, v1
    v_lshlrev_b32 v241, 1, v241
    v_and_b32 v242, 7, v1
    v_xor_b32 v241, v241, v242
    v_lshlrev_b32 v241, 4, v241
    v_lshl_add_u32 v240, v240, 12, v241
    v_add_u32 v241, 31744, v240
    v_add_u32 v242, 63488, v240
    v_add_u32 v243, 95232, v240
    s_sub_u32 s60, s29, 5
    s_lshl_b32 s81, s60, 13
    s_lshl_b32 s80, s60, 18
    s_lshl_b32 s60, s76, 7
    s_add_u32 s80, s80, s60
    s_sub_u32 s60, s29, 5
    s_cmp_lt_u32 s60, 2
    s_cbranch_scc0 Ln56_14
    s_mov_b32 s82, 0
Lpf_15:
    s_and_b32 s60, s66, 15
    s_lshr_b64 s[66:67], s[66:67], 4
    s_lshl_b32 s60, s60, 19
    s_add_u32 s60, s60, s80
    s_add_u32 m0, s81, 0
    s_add_u32 s60, s60, 0
    buffer_load_dwordx4 v240, s[48:51], s60 offen offset:0 lds
    buffer_load_dwordx4 v241, s[48:51], s60 offen offset:1024 lds
    buffer_load_dwordx4 v242, s[48:51], s60 offen offset:2048 lds
    buffer_load_dwordx4 v243, s[48:51], s60 offen offset:3072 lds
    s_add_u32 m0, s81, 4096
    s_add_u32 s60, s60, 131072
    buffer_load_dwordx4 v240, s[48:51], s60 offen offset:0 lds
    buffer_load_dwordx4 v241, s[48:51], s60 offen offset:1024 lds
    buffer_load_dwordx4 v242, s[48:51], s60 offen offset:2048 lds
    buffer_load_dwordx4 v243, s[48:51], s60 offen offset:3072 lds
    s_add_u32 s81, s81, 16384
    s_and_b32 s81, s81, 0x1ffff
    s_add_u32 s82, s82, 1
    s_cmp_lt_u32 s82, 2
    s_cbranch_scc1 Lpf_15
Ln56_14:
    s_barrier
    s_sub_u32 s60, s29, 5
    s_cmp_lt_u32 s60, 2
    s_cbranch_scc0 Ln56_16
    s_mov_b32 s82, 0
Lpf_17:
    s_and_b32 s60, s66, 15
    s_lshr_b64 s[66:67], s[66:67], 4
    s_lshl_b32 s60, s60, 19
    s_add_u32 s60, s60, s80
    s_add_u32 m0, s81, 0
    s_add_u32 s60, s60, 0
    buffer_load_dwordx4 v240, s[48:51], s60 offen offset:0 lds
    buffer_load_dwordx4 v241, s[48:51], s60 offen offset:1024 lds
    buffer_load_dwordx4 v242, s[48:51], s60 offen offset:2048 lds
    buffer_load_dwordx4 v243, s[48:51], s60 offen offset:3072 lds
    s_add_u32 m0, s81, 4096
    s_add_u32 s60, s60, 131072
    buffer_load_dwordx4 v240, s[48:51], s60 offen offset:0 lds
    buffer_load_dwordx4 v241, s[48:51], s60 offen offset:1024 lds
    buffer_load_dwordx4 v242, s[48:51], s60 offen offset:2048 lds
    buffer_load_dwordx4 v243, s[48:51], s60 offen offset:3072 lds
    s_add_u32 s81, s81, 16384
    s_and_b32 s81, s81, 0x1ffff
    s_add_u32 s82, s82, 1
    s_cmp_lt_u32 s82, 2
    s_cbranch_scc1 Lpf_17
Ln56_16:
    s_sub_u32 s60, s29, 5
    s_cmp_lt_u32 s60, 2
    s_cbranch_scc0 Ln56_18
    s_barrier
    s_nop 7
    s_nop 7
    s_mov_b32 s82, 0
Lpf_19:
    s_and_b32 s60, s66, 15
    s_lshr_b64 s[66:67], s[66:67], 4
    s_lshl_b32 s60, s60, 19
    s_add_u32 s60, s60, s80
    s_add_u32 m0, s81, 0
    s_add_u32 s60, s60, 0
    buffer_load_dwordx4 v240, s[48:51], s60 offen offset:0 lds
    buffer_load_dwordx4 v241, s[48:51], s60 offen offset:1024 lds
    buffer_load_dwordx4 v242, s[48:51], s60 offen offset:2048 lds
    buffer_load_dwordx4 v243, s[48:51], s60 offen offset:3072 lds
    s_add_u32 m0, s81, 4096
    s_add_u32 s60, s60, 131072
    buffer_load_dwordx4 v240, s[48:51], s60 offen offset:0 lds
    buffer_load_dwordx4 v241, s[48:51], s60 offen offset:1024 lds
    buffer_load_dwordx4 v242, s[48:51], s60 offen offset:2048 lds
    buffer_load_dwordx4 v243, s[48:51], s60 offen offset:3072 lds
    s_add_u32 s81, s81, 16384
    s_and_b32 s81, s81, 0x1ffff
    s_add_u32 s82, s82, 1
    s_cmp_lt_u32 s82, 4
    s_cbranch_scc1 Lpf_19
    s_branch L_F_loader
Ln56_18:
    s_mul_i32 s60, s72, 24
    s_add_u32 s60, s60, s73
    s_mul_i32 s60, s60, 128
    s_add_u32 s60, s60, 36864
    v_mov_b32 v12, s28
    v_mov_b32 v13, 0
    s_cmp_lg_u32 s29, 7
    s_barrier
    s_cbranch_scc1 L_F_u4
    s_mov_b64 exec, 1
    buffer_store_dword v12, v13, s[32:35], s60 offen sc1
    s_mov_b64 exec, -1
    s_branch L_F_poller
L_helper:
    s_lshl_b32 s83, s30, 1
    s_add_u32 s83, s83, s31
    s_sub_u32 s83, s83, 30
    s_mov_b32 s40, s8
    s_and_b32 s41, s9, 0xffff
    s_mov_b32 s42, 0xc8000
    s_mov_b32 s43, 0x20000
    v_add_u32 v12, 0, v1
    v_mul_u32_u24 v13, 205, v12
    v_lshrrev_b32 v13, 11, v13
    v_mul_u32_u24 v14, 10, v13
    v_sub_u32 v14, v12, v14
    v_lshlrev_b32 v14, 4, v14
    v_mul_u32_u24 v13, 1280, v13
    v_add_u32 v16, v13, v14
    v_add_u32 v12, 64, v1
    v_mul_u32_u24 v13, 205, v12
    v_lshrrev_b32 v13, 11, v13
    v_mul_u32_u24 v14, 10, v13
    v_sub_u32 v14, v12, v14
    v_lshlrev_b32 v14, 4, v14
    v_mul_u32_u24 v13, 1280, v13
    v_add_u32 v17, v13, v14
    v_subrev_u32 v17, 1024, v17
    v_add_u32 v12, 128, v1
    v_mul_u32_u24 v13, 205, v12
    v_lshrrev_b32 v13, 11, v13
    v_mul_u32_u24 v14, 10, v13
    v_sub_u32 v14, v12, v14
    v_lshlrev_b32 v14, 4, v14
    v_mul_u32_u24 v13, 1280, v13
    v_add_u32 v18, v13, v14
    v_subrev_u32 v18, 2048, v18
    v_add_u32 v12, 192, v1
    v_mul_u32_u24 v13, 205, v12
    v_lshrrev_b32 v13, 11, v13
    v_mul_u32_u24 v14, 10, v13
    v_sub_u32 v14, v12, v14
    v_lshlrev_b32 v14, 4, v14
    v_mul_u32_u24 v13, 1280, v13
    v_add_u32 v19, v13, v14
    v_subrev_u32 v19, 3072, v19
    v_add_u32 v12, 256, v1
    v_mul_u32_u24 v13, 205, v12
    v_lshrrev_b32 v13, 11, v13
    v_mul_u32_u24 v14, 10, v13
    v_sub_u32 v14, v12, v14
    v_lshlrev_b32 v14, 4, v14
    v_mul_u32_u24 v13, 1280, v13
    v_add_u32 v20, v13, v14
    s_mov_b32 s82, s29
L_H_ld:
    s_mul_i32 s80, s82, 40960
    s_mul_i32 s60, s83, 160
    s_add_u32 s80, s80, s60
    s_mul_i32 s81, s82, 5120
    s_mov_b32 m0, s81
    s_nop 0
    buffer_load_dwordx4 v16, s[40:43], s80 offen offset:0 lds
    buffer_load_dwordx4 v17, s[40:43], s80 offen offset:1024 lds
    buffer_load_dwordx4 v18, s[40:43], s80 offen offset:2048 lds
    buffer_load_dwordx4 v19, s[40:43], s80 offen offset:3072 lds
    s_add_u32 m0, s81, 4096
    s_nop 0
    buffer_load_dwordx4 v20, s[40:43], s80 offen lds
    s_add_u32 s82, s82, 8
    s_cmp_lt_u32 s82, 20
    s_cbranch_scc1 L_H_ld
    v_and_b32 v12, 15, v1
    v_lshrrev_b32 v13, 4, v1
    v_lshrrev_b32 v14, 2, v12
    v_lshl_add_u32 v14, v13, 2, v14
    v_mul_u32_u24 v14, 160, v14
    v_and_b32 v12, 3, v12
    v_lshl_add_u32 v14, v12, 3, v14
    v_lshlrev_b32 v15, 4, v1
    s_waitcnt vmcnt(0)
    s_barrier
    s_mov_b32 s82, s29
L_H_tr:
    s_lshr_b32 s60, s82, 1
    s_mul_i32 s60, s60, 5
    s_and_b32 s61, s82, 1
    s_lshl_b32 s61, s61, 1
    s_add_u32 s60, s60, s61
    s_add_u32 s61, s60, 1
    s_mul_i32 s62, s82, 10
    s_sub_u32 s62, s62, 156
    s_add_u32 s63, s62, 5
    s_cmp_lt_u32 s82, 16
    s_cselect_b32 s60, s60, s62
    s_cselect_b32 s61, s61, s63
    s_mul_i32 s60, s60, 2560
    s_mul_i32 s61, s61, 2560
    v_add_u32 v12, s60, v14
    v_add_u32 v13, s61, v14
    ds_read_b64_tr_b16 v[24:25], v12 offset:0
    ds_read_b64_tr_b16 v[26:27], v13 offset:0
    ds_read_b64_tr_b16 v[28:29], v12 offset:32
    ds_read_b64_tr_b16 v[30:31], v13 offset:32
    ds_read_b64_tr_b16 v[32:33], v12 offset:64
    ds_read_b64_tr_b16 v[34:35], v13 offset:64
    ds_read_b64_tr_b16 v[36:37], v12 offset:96
    ds_read_b64_tr_b16 v[38:39], v13 offset:96
    ds_read_b64_tr_b16 v[40:41], v12 offset:128
    ds_read_b64_tr_b16 v[42:43], v13 offset:128
    s_mul_i32 s60, s83, 348160
    s_lshl_b32 s61, s82, 10
    s_add_u32 s60, s60, s61
    s_add_u32 s60, s60, 3719168
    s_waitcnt lgkmcnt(8)
    buffer_store_dwordx4 v[24:27], v15, s[32:35], s60 offen sc1
    s_add_u32 s60, s60, 69632
    s_waitcnt lgkmcnt(6)
    buffer_store_dwordx4 v[28:31], v15, s[32:35], s60 offen sc1
    s_add_u32 s60, s60, 69632
    s_waitcnt lgkmcnt(4)
    buffer_store_dwordx4 v[32:35], v15, s[32:35], s60 offen sc1
    s_add_u32 s60, s60, 69632
    s_waitcnt lgkmcnt(2)
    buffer_store_dwordx4 v[36:39], v15, s[32:35], s60 offen sc1
    s_add_u32 s60, s60, 69632
    s_waitcnt lgkmcnt(0)
    buffer_store_dwordx4 v[40:43], v15, s[32:35], s60 offen sc1
    s_add_u32 s82, s82, 8
    s_cmp_lt_u32 s82, 20
    s_cbranch_scc1 L_H_tr
    s_waitcnt vmcnt(0)
    s_barrier
    s_cmp_lg_u32 s29, 7
    s_cbranch_scc1 L_H_nofl
    s_mul_i32 s60, s83, 128
    s_add_u32 s60, s60, 69632
    v_mov_b32 v12, s28
    v_mov_b32 v13, 0
    s_mov_b64 exec, 1
    buffer_store_dword v12, v13, s[32:35], s60 offen sc1
    s_mov_b64 exec, -1
L_H_nofl:
    s_barrier
    v_lshlrev_b32 v12, 7, v1
    s_lshl_b32 s60, s83, 3
    s_add_u32 s60, s60, s29
    s_lshl_b32 s60, s60, 13
    s_add_u32 s60, s60, 4718592
    buffer_load_dword v253, v12, s[48:51], s60 offen
    s_add_u32 s60, s60, 524288
    buffer_load_dword v253, v12, s[48:51], s60 offen
    s_add_u32 s60, s60, 524288
    buffer_load_dword v253, v12, s[48:51], s60 offen
    s_add_u32 s60, s60, 524288
    s_sub_u32 s60, s29, 5
    s_cmp_lt_u32 s60, 2
    s_cbranch_scc0 Ln56_20
    s_lshl_b32 s79, s77, 1
    s_add_u32 s79, s79, s76
    s_and_b32 s79, s79, 7
    s_mov_b32 s66, 0x76543210
    s_mov_b32 s67, 0xba98
    s_cmp_eq_u32 s79, 0
    s_cselect_b32 s66, 0x76543102, s66
    s_cselect_b32 s67, 0xb98a, s67
    s_cmp_eq_u32 s79, 1
    s_cselect_b32 s66, 0x76542130, s66
    s_cselect_b32 s67, 0xa9b8, s67
    s_cmp_eq_u32 s79, 2
    s_cselect_b32 s66, 0x76532410, s66
    s_cselect_b32 s67, 0xba98, s67
    s_cmp_eq_u32 s79, 3
    s_cselect_b32 s66, 0x76435210, s66
    s_cselect_b32 s67, 0xba98, s67
    s_cmp_eq_u32 s79, 4
    s_cselect_b32 s66, 0x75463210, s66
    s_cselect_b32 s67, 0xba98, s67
    s_cmp_eq_u32 s79, 5
    s_cselect_b32 s66, 0x65743210, s66
    s_cselect_b32 s67, 0xba98, s67
    s_cmp_eq_u32 s79, 6
    s_cselect_b32 s66, 0x68543210, s66
    s_cselect_b32 s67, 0xba97, s67
    s_cmp_eq_u32 s79, 7
    s_cselect_b32 s66, 0x96543210, s66
    s_cselect_b32 s67, 0xba87, s67
    v_lshrrev_b32 v240, 3, v1
    v_lshrrev_b32 v241, 4, v1
    v_lshlrev_b32 v241, 1, v241
    v_and_b32 v242, 7, v1
    v_xor_b32 v241, v241, v242
    v_lshlrev_b32 v241, 4, v241
    v_lshl_add_u32 v240, v240, 12, v241
    v_add_u32 v241, 31744, v240
    v_add_u32 v242, 63488, v240
    v_add_u32 v243, 95232, v240
    s_sub_u32 s60, s29, 5
    s_lshl_b32 s81, s60, 13
    s_lshl_b32 s80, s60, 18
    s_lshl_b32 s60, s76, 7
    s_add_u32 s80, s80, s60
    s_mov_b32 s82, 0
Lpf_21:
    s_and_b32 s60, s66, 15
    s_lshr_b64 s[66:67], s[66:67], 4
    s_lshl_b32 s60, s60, 19
    s_add_u32 s60, s60, s80
    s_add_u32 m0, s81, 0
    s_add_u32 s60, s60, 0
    buffer_load_dwordx4 v240, s[48:51], s60 offen offset:0 lds
    buffer_load_dwordx4 v241, s[48:51], s60 offen offset:1024 lds
    buffer_load_dwordx4 v242, s[48:51], s60 offen offset:2048 lds
    buffer_load_dwordx4 v243, s[48:51], s60 offen offset:3072 lds
    s_add_u32 m0, s81, 4096
    s_add_u32 s60, s60, 131072
    buffer_load_dwordx4 v240, s[48:51], s60 offen offset:0 lds
    buffer_load_dwordx4 v241, s[48:51], s60 offen offset:1024 lds
    buffer_load_dwordx4 v242, s[48:51], s60 offen offset:2048 lds
    buffer_load_dwordx4 v243, s[48:51], s60 offen offset:3072 lds
    s_add_u32 s81, s81, 16384
    s_and_b32 s81, s81, 0x1ffff
    s_add_u32 s82, s82, 1
    s_cmp_lt_u32 s82, 8
    s_cbranch_scc1 Lpf_21
    s_branch L_F_loader
Ln56_20:
    s_cmp_lt_u32 s29, 4
    s_cbranch_scc1 L_F_comp
    s_cmp_lg_u32 s29, 7
    s_cbranch_scc1 L_F_u4
    s_branch L_F_poller
L_F_comp:
    s_cmp_eq_u32 s95, 1
    s_cbranch_scc1 L_F_nowot
    s_mul_i32 s60, s77, 5
    s_and_b32 s61, s29, 2
    s_add_u32 s60, s60, s61
    s_mul_i32 s60, s60, 69632
    s_add_u32 s60, s60, 3670016
    s_add_u32 s44, s26, s60
    s_addc_u32 s45, s27, 0
    s_and_b32 s45, s45, 0xffff
    s_mov_b32 s46, 0x22000
    s_mov_b32 s47, 0x20000
    s_and_b32 s60, s29, 1
    s_mul_i32 s61, s60, 71680
    s_mul_i32 s60, s60, 0xfffef800
    s_add_u32 s60, s60, 69632
    v_lshlrev_b32 v12, 4, v1
    v_add_u32 v252, s60, v12
    v_add_u32 v12, s61, v12
    s_mov_b32 s52, s18
    s_and_b32 s53, s19, 0xffff
    s_mov_b32 s54, 0x1000
    s_mov_b32 s55, 0x20000
    s_mov_b32 s56, s22
    s_and_b32 s57, s23, 0xffff
    s_mov_b32 s58, 0x280000
    s_mov_b32 s59, 0x20000
    v_and_b32 v9, 15, v1
    v_lshrrev_b32 v10, 4, v1
    v_lshrrev_b32 v11, 2, v9
    v_lshl_add_u32 v11, v10, 2, v11
    v_bfe_u32 v10, v11, 1, 2
    v_lshlrev_b32 v11, 7, v11
    v_lshl_add_u32 v11, v10, 5, v11
    v_and_b32 v9, 3, v9
    v_lshl_add_u32 v8, v9, 3, v11
    v_xor_b32 v9, 32, v8
    v_xor_b32 v10, 64, v8
    v_xor_b32 v11, 96, v8
    s_and_b32 s62, s29, 1
    s_mul_i32 s83, s77, 5
    s_add_u32 s83, s83, s29
    s_lshl_b32 s60, s62, 13
    v_add_u32 v42, s60, v8
    s_lshl_b32 s62, s62, 11
    v_lshlrev_b32 v51, 4, v1
    v_add_u32 v51, s62, v51
    v_add_u32 v13, 0x20000, v51
    v_and_b32 v47, 15, v1
    v_lshlrev_b32 v43, 1, v47
    v_lshlrev_b32 v47, 2, v47
    v_lshlrev_b32 v55, 3, v1
    v_add_u32 v55, s62, v55
    s_xor_b32 s72, s29, 0
    s_lshl_b32 s60, s72, 5
    v_xor_b32 v4, s60, v42
    s_lshl_b32 s61, s76, 7
    s_add_u32 s60, s60, s61
    buffer_load_ushort v168, v43, s[52:55], s60 offen
    v_add_u32 v8, 0x10000, v4
    s_lshl_b32 s60, s72, 12
    v_add_u32 v52, s60, v55
    s_add_u32 s60, s60, 0x10000
    v_add_u32 v48, s60, v51
    s_xor_b32 s73, s29, 1
    s_lshl_b32 s60, s73, 5
    v_xor_b32 v5, s60, v42
    s_lshl_b32 s61, s76, 7
    s_add_u32 s60, s60, s61
    buffer_load_ushort v169, v43, s[52:55], s60 offen
    v_add_u32 v9, 0x10000, v5
    s_lshl_b32 s60, s73, 12
    v_add_u32 v53, s60, v55
    s_add_u32 s60, s60, 0x10000
    v_add_u32 v49, s60, v51
    s_xor_b32 s74, s29, 2
    s_lshl_b32 s60, s74, 5
    v_xor_b32 v6, s60, v42
    s_lshl_b32 s61, s76, 7
    s_add_u32 s60, s60, s61
    buffer_load_ushort v170, v43, s[52:55], s60 offen
    v_add_u32 v10, 0x10000, v6
    s_lshl_b32 s60, s74, 12
    v_add_u32 v54, s60, v55
    s_add_u32 s60, s60, 0x10000
    v_add_u32 v50, s60, v51
    s_xor_b32 s75, s29, 3
    s_lshl_b32 s60, s75, 5
    v_xor_b32 v7, s60, v42
    s_lshl_b32 s61, s76, 7
    s_add_u32 s60, s60, s61
    buffer_load_ushort v171, v43, s[52:55], s60 offen
    v_add_u32 v11, 0x10000, v7
    s_lshl_b32 s60, s75, 12
    v_add_u32 v55, s60, v55
    s_add_u32 s60, s60, 0x10000
    v_add_u32 v51, s60, v51
    s_lshl_b32 s80, s76, 8
    s_add_u32 s80, s80, 73728
    s_lshl_b32 s79, s77, 1
    s_add_u32 s79, s79, s76
    s_and_b32 s79, s79, 7
    s_mov_b32 s66, 0x76543210
    s_mov_b32 s67, 0xba98
    s_cmp_eq_u32 s79, 0
    s_cselect_b32 s66, 0x76543102, s66
    s_cselect_b32 s67, 0xb98a, s67
    s_cmp_eq_u32 s79, 1
    s_cselect_b32 s66, 0x76542130, s66
    s_cselect_b32 s67, 0xa9b8, s67
    s_cmp_eq_u32 s79, 2
    s_cselect_b32 s66, 0x76532410, s66
    s_cselect_b32 s67, 0xba98, s67
    s_cmp_eq_u32 s79, 3
    s_cselect_b32 s66, 0x76435210, s66
    s_cselect_b32 s67, 0xba98, s67
    s_cmp_eq_u32 s79, 4
    s_cselect_b32 s66, 0x75463210, s66
    s_cselect_b32 s67, 0xba98, s67
    s_cmp_eq_u32 s79, 5
    s_cselect_b32 s66, 0x65743210, s66
    s_cselect_b32 s67, 0xba98, s67
    s_cmp_eq_u32 s79, 6
    s_cselect_b32 s66, 0x68543210, s66
    s_cselect_b32 s67, 0xba97, s67
    s_cmp_eq_u32 s79, 7
    s_cselect_b32 s66, 0x96543210, s66
    s_cselect_b32 s67, 0xba87, s67
    s_barrier
    s_mov_b32 s82, 49152
    buffer_load_dwordx4 v[172:175], v12, s[44:47], s82 offen offset:0 sc1
    buffer_load_dwordx4 v[176:179], v252, s[44:47], s82 offen offset:0 sc1
    buffer_load_dwordx4 v[180:183], v12, s[44:47], s82 offen offset:1024 sc1
    buffer_load_dwordx4 v[184:187], v252, s[44:47], s82 offen offset:1024 sc1
    s_mov_b32 s82, 53248
    buffer_load_dwordx4 v[188:191], v12, s[44:47], s82 offen offset:0 sc1
    buffer_load_dwordx4 v[192:195], v252, s[44:47], s82 offen offset:0 sc1
    buffer_load_dwordx4 v[196:199], v12, s[44:47], s82 offen offset:1024 sc1
    buffer_load_dwordx4 v[200:203], v252, s[44:47], s82 offen offset:1024 sc1
    s_mov_b32 s82, 57344
    buffer_load_dwordx4 v[204:207], v12, s[44:47], s82 offen offset:0 sc1
    buffer_load_dwordx4 v[208:211], v252, s[44:47], s82 offen offset:0 sc1
    buffer_load_dwordx4 v[212:215], v12, s[44:47], s82 offen offset:1024 sc1
    buffer_load_dwordx4 v[216:219], v252, s[44:47], s82 offen offset:1024 sc1
    s_mov_b32 s82, 61440
    buffer_load_dwordx4 v[220:223], v12, s[44:47], s82 offen offset:0 sc1
    buffer_load_dwordx4 v[224:227], v252, s[44:47], s82 offen offset:0 sc1
    buffer_load_dwordx4 v[228:231], v12, s[44:47], s82 offen offset:1024 sc1
    buffer_load_dwordx4 v[232:235], v252, s[44:47], s82 offen offset:1024 sc1
    s_mov_b32 s82, 65536
    buffer_load_dwordx4 v[236:239], v12, s[44:47], s82 offen offset:0 sc1
    buffer_load_dwordx4 v[240:243], v252, s[44:47], s82 offen offset:0 sc1
    buffer_load_dwordx4 v[244:247], v12, s[44:47], s82 offen offset:1024 sc1
    buffer_load_dwordx4 v[248:251], v252, s[44:47], s82 offen offset:1024 sc1
L_F_nowot:
    s_and_b32 s82, s66, 15
    s_lshr_b64 s[66:67], s[66:67], 4
    s_lshl_b32 s82, s82, 12
    s_barrier
    buffer_load_dwordx4 v[64:67], v12, s[44:47], s82 offen offset:0 sc1
    buffer_load_dwordx4 v[68:71], v252, s[44:47], s82 offen offset:0 sc1
    buffer_load_dwordx4 v[72:75], v12, s[44:47], s82 offen offset:1024 sc1
    buffer_load_dwordx4 v[76:79], v252, s[44:47], s82 offen offset:1024 sc1
    s_and_b32 s90, s66, 15
    s_lshr_b64 s[66:67], s[66:67], 4
    s_lshl_b32 s90, s90, 12
    s_and_b32 s91, s66, 15
    s_lshr_b64 s[66:67], s[66:67], 4
    s_lshl_b32 s91, s91, 12
    s_and_b32 s82, s66, 15
    s_lshr_b64 s[66:67], s[66:67], 4
    s_lshl_b32 s82, s82, 12
    s_barrier
    ds_read_b128 v[36:39], v13 offset:0
    ds_read_b64_tr_b16 v[112:113], v4 offset:0
    ds_read_b64_tr_b16 v[114:115], v4 offset:2048
    ds_read_b64_tr_b16 v[116:117], v5 offset:0
    ds_read_b64_tr_b16 v[118:119], v5 offset:2048
    ds_read_b64_tr_b16 v[120:121], v6 offset:0
    ds_read_b64_tr_b16 v[122:123], v6 offset:2048
    ds_read_b64_tr_b16 v[124:125], v7 offset:0
    ds_read_b64_tr_b16 v[126:127], v7 offset:2048
    ds_read_b128 v[40:43], v13 offset:1024
    ds_read_b64_tr_b16 v[128:129], v4 offset:4096
    ds_read_b64_tr_b16 v[130:131], v4 offset:6144
    s_waitcnt vmcnt(2) lgkmcnt(7)
    v_mfma_f32_16x16x32_bf16 v[144:147], v[64:67], v[112:115], 0
    ds_read_b64_tr_b16 v[132:133], v5 offset:4096
    v_mfma_f32_16x16x32_bf16 v[16:19], v[68:71], v[112:115], 0
    ds_read_b64_tr_b16 v[134:135], v5 offset:6144
    v_mfma_f32_16x16x32_bf16 v[160:163], v[36:39], v[112:115], 0
    v_mfma_f32_16x16x32_bf16 v[148:151], v[64:67], v[116:119], 0
    buffer_load_dwordx4 v[80:83], v12, s[44:47], s90 offen offset:0 sc1
    ds_read_b64_tr_b16 v[136:137], v6 offset:4096
    v_mfma_f32_16x16x32_bf16 v[20:23], v[68:71], v[116:119], 0
    buffer_load_dwordx4 v[84:87], v252, s[44:47], s90 offen offset:0 sc1
    v_mfma_f32_16x16x32_bf16 v[164:167], v[36:39], v[116:119], 0
    ds_read_b64_tr_b16 v[138:139], v6 offset:6144
    s_waitcnt lgkmcnt(7)
    v_mfma_f32_16x16x32_bf16 v[152:155], v[64:67], v[120:123], 0
    buffer_load_dwordx4 v[96:99], v12, s[44:47], s91 offen offset:0 sc1
    ds_read_b64_tr_b16 v[140:141], v7 offset:4096
    v_mfma_f32_16x16x32_bf16 v[24:27], v[68:71], v[120:123], 0
    buffer_load_dwordx4 v[100:103], v252, s[44:47], s91 offen offset:0 sc1
    ds_read_b64_tr_b16 v[142:143], v7 offset:6144
    s_barrier
    v_mfma_f32_16x16x32_bf16 v[156:159], v[64:67], v[124:127], 0
    ds_read_b128 v[36:39], v13 offset:4096
    ds_read_b64_tr_b16 v[112:113], v4 offset:16384
    v_mfma_f32_16x16x32_bf16 v[28:31], v[68:71], v[124:127], 0
    ds_read_b64_tr_b16 v[114:115], v4 offset:18432
    s_waitcnt vmcnt(4) lgkmcnt(7)
    v_mfma_f32_16x16x32_bf16 v[144:147], v[72:75], v[128:131], v[144:147]
    buffer_load_dwordx4 v[64:67], v12, s[44:47], s82 offen offset:0 sc1
    ds_read_b64_tr_b16 v[116:117], v5 offset:16384
    v_mfma_f32_16x16x32_bf16 v[16:19], v[76:79], v[128:131], v[16:19]
    buffer_load_dwordx4 v[68:71], v252, s[44:47], s82 offen offset:0 sc1
    v_mfma_f32_16x16x32_bf16 v[160:163], v[40:43], v[128:131], v[160:163]
    ds_read_b64_tr_b16 v[118:119], v5 offset:18432
    v_mfma_f32_16x16x32_bf16 v[148:151], v[72:75], v[132:135], v[148:151]
    buffer_load_dwordx4 v[88:91], v12, s[44:47], s90 offen offset:1024 sc1
    ds_read_b64_tr_b16 v[120:121], v6 offset:16384
    v_mfma_f32_16x16x32_bf16 v[20:23], v[76:79], v[132:135], v[20:23]
    buffer_load_dwordx4 v[92:95], v252, s[44:47], s90 offen offset:1024 sc1
    v_mfma_f32_16x16x32_bf16 v[164:167], v[40:43], v[132:135], v[164:167]
    ds_read_b64_tr_b16 v[122:123], v6 offset:18432
    s_waitcnt lgkmcnt(7)
    v_mfma_f32_16x16x32_bf16 v[152:155], v[72:75], v[136:139], v[152:155]
    buffer_load_dwordx4 v[104:107], v12, s[44:47], s91 offen offset:1024 sc1
    ds_read_b64_tr_b16 v[124:125], v7 offset:16384
    v_mfma_f32_16x16x32_bf16 v[24:27], v[76:79], v[136:139], v[24:27]
    buffer_load_dwordx4 v[108:111], v252, s[44:47], s91 offen offset:1024 sc1
    ds_read_b64_tr_b16 v[126:127], v7 offset:18432
    v_mfma_f32_16x16x32_bf16 v[156:159], v[72:75], v[140:143], v[156:159]
    ds_read_b128 v[40:43], v13 offset:5120
    ds_read_b64_tr_b16 v[128:129], v4 offset:20480
    v_mfma_f32_16x16x32_bf16 v[28:31], v[76:79], v[140:143], v[28:31]
    ds_read_b64_tr_b16 v[130:131], v4 offset:22528
    buffer_load_dwordx4 v[72:75], v12, s[44:47], s82 offen offset:1024 sc1
    buffer_load_dwordx4 v[76:79], v252, s[44:47], s82 offen offset:1024 sc1
    s_and_b32 s82, s66, 15
    s_lshr_b64 s[66:67], s[66:67], 4
    s_lshl_b32 s82, s82, 12
    s_waitcnt vmcnt(10) lgkmcnt(7)
    v_mfma_f32_16x16x32_bf16 v[144:147], v[80:83], v[112:115], v[144:147]
    ds_read_b64_tr_b16 v[132:133], v5 offset:20480
    v_mfma_f32_16x16x32_bf16 v[16:19], v[84:87], v[112:115], v[16:19]
    ds_read_b64_tr_b16 v[134:135], v5 offset:22528
    v_mfma_f32_16x16x32_bf16 v[160:163], v[36:39], v[112:115], v[160:163]
    v_mfma_f32_16x16x32_bf16 v[148:151], v[80:83], v[116:119], v[148:151]
    s_lshl_b32 s60, s72, 6
    ds_read_b64_tr_b16 v[136:137], v6 offset:20480
    v_mfma_f32_16x16x32_bf16 v[20:23], v[84:87], v[116:119], v[20:23]
    s_add_u32 s60, s60, s80
    ds_read_b64_tr_b16 v[138:139], v6 offset:22528
    v_mfma_f32_16x16x32_bf16 v[164:167], v[36:39], v[116:119], v[164:167]
    buffer_load_dword v56, v47, s[32:35], s60 offen sc1
    s_waitcnt lgkmcnt(7)
    v_mfma_f32_16x16x32_bf16 v[152:155], v[80:83], v[120:123], v[152:155]
    s_lshl_b32 s60, s73, 6
    ds_read_b64_tr_b16 v[140:141], v7 offset:20480
    s_add_u32 s60, s60, s80
    v_mfma_f32_16x16x32_bf16 v[24:27], v[84:87], v[120:123], v[24:27]
    ds_read_b64_tr_b16 v[142:143], v7 offset:22528
    buffer_load_dword v57, v47, s[32:35], s60 offen sc1
    s_barrier
    v_mfma_f32_16x16x32_bf16 v[156:159], v[80:83], v[124:127], v[156:159]
    ds_read_b128 v[36:39], v13 offset:8192
    ds_read_b64_tr_b16 v[112:113], v4 offset:32768
    v_mfma_f32_16x16x32_bf16 v[28:31], v[84:87], v[124:127], v[28:31]
    ds_read_b64_tr_b16 v[114:115], v4 offset:34816
    s_waitcnt vmcnt(6) lgkmcnt(7)
    v_mfma_f32_16x16x32_bf16 v[144:147], v[88:91], v[128:131], v[144:147]
    buffer_load_dwordx4 v[80:83], v12, s[44:47], s82 offen offset:0 sc1
    ds_read_b64_tr_b16 v[116:117], v5 offset:32768
    v_mfma_f32_16x16x32_bf16 v[16:19], v[92:95], v[128:131], v[16:19]
    buffer_load_dwordx4 v[84:87], v252, s[44:47], s82 offen offset:0 sc1
    v_mfma_f32_16x16x32_bf16 v[160:163], v[40:43], v[128:131], v[160:163]
    ds_read_b64_tr_b16 v[118:119], v5 offset:34816
    v_mfma_f32_16x16x32_bf16 v[148:151], v[88:91], v[132:135], v[148:151]
    s_lshl_b32 s60, s74, 6
    ds_read_b64_tr_b16 v[120:121], v6 offset:32768
    v_mfma_f32_16x16x32_bf16 v[20:23], v[92:95], v[132:135], v[20:23]
    s_add_u32 s60, s60, s80
    ds_read_b64_tr_b16 v[122:123], v6 offset:34816
    v_mfma_f32_16x16x32_bf16 v[164:167], v[40:43], v[132:135], v[164:167]
    buffer_load_dword v58, v47, s[32:35], s60 offen sc1
    s_waitcnt lgkmcnt(7)
    v_mfma_f32_16x16x32_bf16 v[152:155], v[88:91], v[136:139], v[152:155]
    s_lshl_b32 s60, s75, 6
    ds_read_b64_tr_b16 v[124:125], v7 offset:32768
    s_add_u32 s60, s60, s80
    v_mfma_f32_16x16x32_bf16 v[24:27], v[92:95], v[136:139], v[24:27]
    ds_read_b64_tr_b16 v[126:127], v7 offset:34816
    buffer_load_dword v59, v47, s[32:35], s60 offen sc1
    v_mfma_f32_16x16x32_bf16 v[156:159], v[88:91], v[140:143], v[156:159]
    ds_read_b128 v[40:43], v13 offset:9216
    ds_read_b64_tr_b16 v[128:129], v4 offset:36864
    v_mfma_f32_16x16x32_bf16 v[28:31], v[92:95], v[140:143], v[28:31]
    ds_read_b64_tr_b16 v[130:131], v4 offset:38912
    buffer_load_dwordx4 v[88:91], v12, s[44:47], s82 offen offset:1024 sc1
    buffer_load_dwordx4 v[92:95], v252, s[44:47], s82 offen offset:1024 sc1
    s_and_b32 s82, s66, 15
    s_lshr_b64 s[66:67], s[66:67], 4
    s_lshl_b32 s82, s82, 12
    s_waitcnt vmcnt(16) lgkmcnt(7)
    v_mfma_f32_16x16x32_bf16 v[144:147], v[96:99], v[112:115], v[144:147]
    ds_read_b64_tr_b16 v[132:133], v5 offset:36864
    v_mfma_f32_16x16x32_bf16 v[16:19], v[100:103], v[112:115], v[16:19]
    ds_read_b64_tr_b16 v[134:135], v5 offset:38912
    v_mfma_f32_16x16x32_bf16 v[160:163], v[36:39], v[112:115], v[160:163]
    v_mfma_f32_16x16x32_bf16 v[148:151], v[96:99], v[116:119], v[148:151]
    ds_read_b64_tr_b16 v[136:137], v6 offset:36864
    v_mfma_f32_16x16x32_bf16 v[20:23], v[100:103], v[116:119], v[20:23]
    ds_read_b64_tr_b16 v[138:139], v6 offset:38912
    v_mfma_f32_16x16x32_bf16 v[164:167], v[36:39], v[116:119], v[164:167]
    s_waitcnt lgkmcnt(7)
    v_mfma_f32_16x16x32_bf16 v[152:155], v[96:99], v[120:123], v[152:155]
    ds_read_b64_tr_b16 v[140:141], v7 offset:36864
    v_mfma_f32_16x16x32_bf16 v[24:27], v[100:103], v[120:123], v[24:27]
    ds_read_b64_tr_b16 v[142:143], v7 offset:38912
    s_barrier
    v_mfma_f32_16x16x32_bf16 v[156:159], v[96:99], v[124:127], v[156:159]
    ds_read_b128 v[36:39], v13 offset:12288
    ds_read_b64_tr_b16 v[112:113], v4 offset:49152
    v_mfma_f32_16x16x32_bf16 v[28:31], v[100:103], v[124:127], v[28:31]
    ds_read_b64_tr_b16 v[114:115], v4 offset:51200
    s_waitcnt vmcnt(10) lgkmcnt(7)
    v_mfma_f32_16x16x32_bf16 v[144:147], v[104:107], v[128:131], v[144:147]
    buffer_load_dwordx4 v[96:99], v12, s[44:47], s82 offen offset:0 sc1
    ds_read_b64_tr_b16 v[116:117], v5 offset:49152
    v_mfma_f32_16x16x32_bf16 v[16:19], v[108:111], v[128:131], v[16:19]
    buffer_load_dwordx4 v[100:103], v252, s[44:47], s82 offen offset:0 sc1
    v_mfma_f32_16x16x32_bf16 v[160:163], v[40:43], v[128:131], v[160:163]
    ds_read_b64_tr_b16 v[118:119], v5 offset:51200
    v_mfma_f32_16x16x32_bf16 v[148:151], v[104:107], v[132:135], v[148:151]
    ds_read_b64_tr_b16 v[120:121], v6 offset:49152
    v_mfma_f32_16x16x32_bf16 v[20:23], v[108:111], v[132:135], v[20:23]
    ds_read_b64_tr_b16 v[122:123], v6 offset:51200
    v_mfma_f32_16x16x32_bf16 v[164:167], v[40:43], v[132:135], v[164:167]
    s_waitcnt lgkmcnt(7)
    v_mfma_f32_16x16x32_bf16 v[152:155], v[104:107], v[136:139], v[152:155]
    ds_read_b64_tr_b16 v[124:125], v7 offset:49152
    v_mfma_f32_16x16x32_bf16 v[24:27], v[108:111], v[136:139], v[24:27]
    ds_read_b64_tr_b16 v[126:127], v7 offset:51200
    v_mfma_f32_16x16x32_bf16 v[156:159], v[104:107], v[140:143], v[156:159]
    ds_read_b128 v[40:43], v13 offset:13312
    ds_read_b64_tr_b16 v[128:129], v4 offset:53248
    v_mfma_f32_16x16x32_bf16 v[28:31], v[108:111], v[140:143], v[28:31]
    ds_read_b64_tr_b16 v[130:131], v4 offset:55296
    buffer_load_dwordx4 v[104:107], v12, s[44:47], s82 offen offset:1024 sc1
    buffer_load_dwordx4 v[108:111], v252, s[44:47], s82 offen offset:1024 sc1
    s_and_b32 s82, s66, 15
    s_lshr_b64 s[66:67], s[66:67], 4
    s_lshl_b32 s82, s82, 12
    s_waitcnt vmcnt(18) lgkmcnt(7)
    v_mfma_f32_16x16x32_bf16 v[144:147], v[64:67], v[112:115], v[144:147]
    ds_read_b64_tr_b16 v[132:133], v5 offset:53248
    v_mfma_f32_16x16x32_bf16 v[16:19], v[68:71], v[112:115], v[16:19]
    ds_read_b64_tr_b16 v[134:135], v5 offset:55296
    v_mfma_f32_16x16x32_bf16 v[160:163], v[36:39], v[112:115], v[160:163]
    v_mfma_f32_16x16x32_bf16 v[148:151], v[64:67], v[116:119], v[148:151]
    ds_read_b64_tr_b16 v[136:137], v6 offset:53248
    v_mfma_f32_16x16x32_bf16 v[20:23], v[68:71], v[116:119], v[20:23]
    ds_read_b64_tr_b16 v[138:139], v6 offset:55296
    v_mfma_f32_16x16x32_bf16 v[164:167], v[36:39], v[116:119], v[164:167]
    s_waitcnt lgkmcnt(7)
    v_mfma_f32_16x16x32_bf16 v[152:155], v[64:67], v[120:123], v[152:155]
    ds_read_b64_tr_b16 v[140:141], v7 offset:53248
    v_mfma_f32_16x16x32_bf16 v[24:27], v[68:71], v[120:123], v[24:27]
    ds_read_b64_tr_b16 v[142:143], v7 offset:55296
    s_barrier
    v_mfma_f32_16x16x32_bf16 v[156:159], v[64:67], v[124:127], v[156:159]
    ds_read_b128 v[36:39], v13 offset:16384
    ds_read_b64_tr_b16 v[112:113], v8 offset:0
    v_mfma_f32_16x16x32_bf16 v[28:31], v[68:71], v[124:127], v[28:31]
    ds_read_b64_tr_b16 v[114:115], v8 offset:2048
    s_waitcnt vmcnt(12) lgkmcnt(7)
    v_mfma_f32_16x16x32_bf16 v[144:147], v[72:75], v[128:131], v[144:147]
    buffer_load_dwordx4 v[64:67], v12, s[44:47], s82 offen offset:0 sc1
    ds_read_b64_tr_b16 v[116:117], v9 offset:0
    v_mfma_f32_16x16x32_bf16 v[16:19], v[76:79], v[128:131], v[16:19]
    buffer_load_dwordx4 v[68:71], v252, s[44:47], s82 offen offset:0 sc1
    v_mfma_f32_16x16x32_bf16 v[160:163], v[40:43], v[128:131], v[160:163]
    ds_read_b64_tr_b16 v[118:119], v9 offset:2048
    v_mfma_f32_16x16x32_bf16 v[148:151], v[72:75], v[132:135], v[148:151]
    ds_read_b64_tr_b16 v[120:121], v10 offset:0
    v_mfma_f32_16x16x32_bf16 v[20:23], v[76:79], v[132:135], v[20:23]
    ds_read_b64_tr_b16 v[122:123], v10 offset:2048
    v_mfma_f32_16x16x32_bf16 v[164:167], v[40:43], v[132:135], v[164:167]
    s_waitcnt lgkmcnt(7)
    v_mfma_f32_16x16x32_bf16 v[152:155], v[72:75], v[136:139], v[152:155]
    ds_read_b64_tr_b16 v[124:125], v11 offset:0
    v_mfma_f32_16x16x32_bf16 v[24:27], v[76:79], v[136:139], v[24:27]
    ds_read_b64_tr_b16 v[126:127], v11 offset:2048
    v_mfma_f32_16x16x32_bf16 v[156:159], v[72:75], v[140:143], v[156:159]
    ds_read_b128 v[40:43], v13 offset:17408
    ds_read_b64_tr_b16 v[128:129], v8 offset:4096
    v_mfma_f32_16x16x32_bf16 v[28:31], v[76:79], v[140:143], v[28:31]
    ds_read_b64_tr_b16 v[130:131], v8 offset:6144
    buffer_load_dwordx4 v[72:75], v12, s[44:47], s82 offen offset:1024 sc1
    buffer_load_dwordx4 v[76:79], v252, s[44:47], s82 offen offset:1024 sc1
    s_and_b32 s82, s66, 15
    s_lshr_b64 s[66:67], s[66:67], 4
    s_lshl_b32 s82, s82, 12
    s_waitcnt vmcnt(12) lgkmcnt(7)
    v_mfma_f32_16x16x32_bf16 v[144:147], v[80:83], v[112:115], v[144:147]
    ds_read_b64_tr_b16 v[132:133], v9 offset:4096
    v_mfma_f32_16x16x32_bf16 v[16:19], v[84:87], v[112:115], v[16:19]
    ds_read_b64_tr_b16 v[134:135], v9 offset:6144
    v_mfma_f32_16x16x32_bf16 v[160:163], v[36:39], v[112:115], v[160:163]
    v_mfma_f32_16x16x32_bf16 v[148:151], v[80:83], v[116:119], v[148:151]
    ds_read_b64_tr_b16 v[136:137], v10 offset:4096
    v_mfma_f32_16x16x32_bf16 v[20:23], v[84:87], v[116:119], v[20:23]
    ds_read_b64_tr_b16 v[138:139], v10 offset:6144
    v_mfma_f32_16x16x32_bf16 v[164:167], v[36:39], v[116:119], v[164:167]
    s_waitcnt lgkmcnt(7)
    v_mfma_f32_16x16x32_bf16 v[152:155], v[80:83], v[120:123], v[152:155]
    ds_read_b64_tr_b16 v[140:141], v11 offset:4096
    v_mfma_f32_16x16x32_bf16 v[24:27], v[84:87], v[120:123], v[24:27]
    ds_read_b64_tr_b16 v[142:143], v11 offset:6144
    s_barrier
    v_mfma_f32_16x16x32_bf16 v[156:159], v[80:83], v[124:127], v[156:159]
    ds_read_b128 v[36:39], v13 offset:20480
    ds_read_b64_tr_b16 v[112:113], v8 offset:16384
    v_mfma_f32_16x16x32_bf16 v[28:31], v[84:87], v[124:127], v[28:31]
    ds_read_b64_tr_b16 v[114:115], v8 offset:18432
    s_waitcnt vmcnt(8) lgkmcnt(7)
    v_mfma_f32_16x16x32_bf16 v[144:147], v[88:91], v[128:131], v[144:147]
    buffer_load_dwordx4 v[80:83], v12, s[44:47], s82 offen offset:0 sc1
    ds_read_b64_tr_b16 v[116:117], v9 offset:16384
    v_mfma_f32_16x16x32_bf16 v[16:19], v[92:95], v[128:131], v[16:19]
    buffer_load_dwordx4 v[84:87], v252, s[44:47], s82 offen offset:0 sc1
    v_mfma_f32_16x16x32_bf16 v[160:163], v[40:43], v[128:131], v[160:163]
    ds_read_b64_tr_b16 v[118:119], v9 offset:18432
    v_mfma_f32_16x16x32_bf16 v[148:151], v[88:91], v[132:135], v[148:151]
    ds_read_b64_tr_b16 v[120:121], v10 offset:16384
    v_mfma_f32_16x16x32_bf16 v[20:23], v[92:95], v[132:135], v[20:23]
    ds_read_b64_tr_b16 v[122:123], v10 offset:18432
    v_mfma_f32_16x16x32_bf16 v[164:167], v[40:43], v[132:135], v[164:167]
    s_waitcnt lgkmcnt(7)
    v_mfma_f32_16x16x32_bf16 v[152:155], v[88:91], v[136:139], v[152:155]
    ds_read_b64_tr_b16 v[124:125], v11 offset:16384
    v_mfma_f32_16x16x32_bf16 v[24:27], v[92:95], v[136:139], v[24:27]
    ds_read_b64_tr_b16 v[126:127], v11 offset:18432
    v_mfma_f32_16x16x32_bf16 v[156:159], v[88:91], v[140:143], v[156:159]
    ds_read_b128 v[40:43], v13 offset:21504
    ds_read_b64_tr_b16 v[128:129], v8 offset:20480
    v_mfma_f32_16x16x32_bf16 v[28:31], v[92:95], v[140:143], v[28:31]
    ds_read_b64_tr_b16 v[130:131], v8 offset:22528
    buffer_load_dwordx4 v[88:91], v12, s[44:47], s82 offen offset:1024 sc1
    buffer_load_dwordx4 v[92:95], v252, s[44:47], s82 offen offset:1024 sc1
    s_and_b32 s82, s66, 15
    s_lshr_b64 s[66:67], s[66:67], 4
    s_lshl_b32 s82, s82, 12
    s_waitcnt vmcnt(10) lgkmcnt(7)
    v_mfma_f32_16x16x32_bf16 v[144:147], v[96:99], v[112:115], v[144:147]
    ds_read_b64_tr_b16 v[132:133], v9 offset:20480
    v_mfma_f32_16x16x32_bf16 v[16:19], v[100:103], v[112:115], v[16:19]
    ds_read_b64_tr_b16 v[134:135], v9 offset:22528
    v_mfma_f32_16x16x32_bf16 v[160:163], v[36:39], v[112:115], v[160:163]
    v_mfma_f32_16x16x32_bf16 v[148:151], v[96:99], v[116:119], v[148:151]
    ds_read_b64_tr_b16 v[136:137], v10 offset:20480
    v_mfma_f32_16x16x32_bf16 v[20:23], v[100:103], v[116:119], v[20:23]
    ds_read_b64_tr_b16 v[138:139], v10 offset:22528
    v_mfma_f32_16x16x32_bf16 v[164:167], v[36:39], v[116:119], v[164:167]
    s_waitcnt lgkmcnt(7)
    v_mfma_f32_16x16x32_bf16 v[152:155], v[96:99], v[120:123], v[152:155]
    ds_read_b64_tr_b16 v[140:141], v11 offset:20480
    v_mfma_f32_16x16x32_bf16 v[24:27], v[100:103], v[120:123], v[24:27]
    ds_read_b64_tr_b16 v[142:143], v11 offset:22528
    s_barrier
    v_mfma_f32_16x16x32_bf16 v[156:159], v[96:99], v[124:127], v[156:159]
    ds_read_b128 v[36:39], v13 offset:24576
    ds_read_b64_tr_b16 v[112:113], v8 offset:32768
    v_mfma_f32_16x16x32_bf16 v[28:31], v[100:103], v[124:127], v[28:31]
    ds_read_b64_tr_b16 v[114:115], v8 offset:34816
    s_waitcnt vmcnt(8) lgkmcnt(7)
    v_mfma_f32_16x16x32_bf16 v[144:147], v[104:107], v[128:131], v[144:147]
    buffer_load_dwordx4 v[96:99], v12, s[44:47], s82 offen offset:0 sc1
    ds_read_b64_tr_b16 v[116:117], v9 offset:32768
    v_mfma_f32_16x16x32_bf16 v[16:19], v[108:111], v[128:131], v[16:19]
    buffer_load_dwordx4 v[100:103], v252, s[44:47], s82 offen offset:0 sc1
    v_mfma_f32_16x16x32_bf16 v[160:163], v[40:43], v[128:131], v[160:163]
    ds_read_b64_tr_b16 v[118:119], v9 offset:34816
    v_mfma_f32_16x16x32_bf16 v[148:151], v[104:107], v[132:135], v[148:151]
    ds_read_b64_tr_b16 v[120:121], v10 offset:32768
    v_mfma_f32_16x16x32_bf16 v[20:23], v[108:111], v[132:135], v[20:23]
    ds_read_b64_tr_b16 v[122:123], v10 offset:34816
    v_mfma_f32_16x16x32_bf16 v[164:167], v[40:43], v[132:135], v[164:167]
    s_waitcnt lgkmcnt(7)
    v_mfma_f32_16x16x32_bf16 v[152:155], v[104:107], v[136:139], v[152:155]
    ds_read_b64_tr_b16 v[124:125], v11 offset:32768
    v_mfma_f32_16x16x32_bf16 v[24:27], v[108:111], v[136:139], v[24:27]
    ds_read_b64_tr_b16 v[126:127], v11 offset:34816
    v_mfma_f32_16x16x32_bf16 v[156:159], v[104:107], v[140:143], v[156:159]
    ds_read_b128 v[40:43], v13 offset:25600
    ds_read_b64_tr_b16 v[128:129], v8 offset:36864
    v_mfma_f32_16x16x32_bf16 v[28:31], v[108:111], v[140:143], v[28:31]
    ds_read_b64_tr_b16 v[130:131], v8 offset:38912
    buffer_load_dwordx4 v[104:107], v12, s[44:47], s82 offen offset:1024 sc1
    buffer_load_dwordx4 v[108:111], v252, s[44:47], s82 offen offset:1024 sc1
    s_and_b32 s82, s66, 15
    s_lshr_b64 s[66:67], s[66:67], 4
    s_lshl_b32 s82, s82, 12
    s_waitcnt vmcnt(10) lgkmcnt(7)
    v_mfma_f32_16x16x32_bf16 v[144:147], v[64:67], v[112:115], v[144:147]
    ds_read_b64_tr_b16 v[132:133], v9 offset:36864
    v_mfma_f32_16x16x32_bf16 v[16:19], v[68:71], v[112:115], v[16:19]
    ds_read_b64_tr_b16 v[134:135], v9 offset:38912
    v_mfma_f32_16x16x32_bf16 v[160:163], v[36:39], v[112:115], v[160:163]
    v_mfma_f32_16x16x32_bf16 v[148:151], v[64:67], v[116:119], v[148:151]
    ds_read_b64_tr_b16 v[136:137], v10 offset:36864
    v_mfma_f32_16x16x32_bf16 v[20:23], v[68:71], v[116:119], v[20:23]
    ds_read_b64_tr_b16 v[138:139], v10 offset:38912
    v_mfma_f32_16x16x32_bf16 v[164:167], v[36:39], v[116:119], v[164:167]
    s_waitcnt lgkmcnt(7)
    v_mfma_f32_16x16x32_bf16 v[152:155], v[64:67], v[120:123], v[152:155]
    ds_read_b64_tr_b16 v[140:141], v11 offset:36864
    v_mfma_f32_16x16x32_bf16 v[24:27], v[68:71], v[120:123], v[24:27]
    ds_read_b64_tr_b16 v[142:143], v11 offset:38912
    s_barrier
    v_mfma_f32_16x16x32_bf16 v[156:159], v[64:67], v[124:127], v[156:159]
    ds_read_b128 v[36:39], v13 offset:28672
    ds_read_b64_tr_b16 v[112:113], v8 offset:49152
    v_mfma_f32_16x16x32_bf16 v[28:31], v[68:71], v[124:127], v[28:31]
    ds_read_b64_tr_b16 v[114:115], v8 offset:51200
    s_waitcnt vmcnt(8) lgkmcnt(7)
    v_mfma_f32_16x16x32_bf16 v[144:147], v[72:75], v[128:131], v[144:147]
    buffer_load_dwordx4 v[64:67], v12, s[44:47], s82 offen offset:0 sc1
    ds_read_b64_tr_b16 v[116:117], v9 offset:49152
    v_mfma_f32_16x16x32_bf16 v[16:19], v[76:79], v[128:131], v[16:19]
    buffer_load_dwordx4 v[68:71], v252, s[44:47], s82 offen offset:0 sc1
    v_mfma_f32_16x16x32_bf16 v[160:163], v[40:43], v[128:131], v[160:163]
    ds_read_b64_tr_b16 v[118:119], v9 offset:51200
    v_mfma_f32_16x16x32_bf16 v[148:151], v[72:75], v[132:135], v[148:151]
    ds_read_b64_tr_b16 v[120:121], v10 offset:49152
    v_mfma_f32_16x16x32_bf16 v[20:23], v[76:79], v[132:135], v[20:23]
    ds_read_b64_tr_b16 v[122:123], v10 offset:51200
    v_mfma_f32_16x16x32_bf16 v[164:167], v[40:43], v[132:135], v[164:167]
    s_waitcnt lgkmcnt(7)
    v_mfma_f32_16x16x32_bf16 v[152:155], v[72:75], v[136:139], v[152:155]
    ds_read_b64_tr_b16 v[124:125], v11 offset:49152
    v_mfma_f32_16x16x32_bf16 v[24:27], v[76:79], v[136:139], v[24:27]
    ds_read_b64_tr_b16 v[126:127], v11 offset:51200
    v_mfma_f32_16x16x32_bf16 v[156:159], v[72:75], v[140:143], v[156:159]
    ds_read_b128 v[40:43], v13 offset:29696
    ds_read_b64_tr_b16 v[128:129], v8 offset:53248
    v_mfma_f32_16x16x32_bf16 v[28:31], v[76:79], v[140:143], v[28:31]
    ds_read_b64_tr_b16 v[130:131], v8 offset:55296
    buffer_load_dwordx4 v[72:75], v12, s[44:47], s82 offen offset:1024 sc1
    buffer_load_dwordx4 v[76:79], v252, s[44:47], s82 offen offset:1024 sc1
    s_and_b32 s82, s66, 15
    s_lshr_b64 s[66:67], s[66:67], 4
    s_lshl_b32 s82, s82, 12
    s_waitcnt vmcnt(10) lgkmcnt(7)
    v_mfma_f32_16x16x32_bf16 v[144:147], v[80:83], v[112:115], v[144:147]
    ds_read_b64_tr_b16 v[132:133], v9 offset:53248
    v_mfma_f32_16x16x32_bf16 v[16:19], v[84:87], v[112:115], v[16:19]
    ds_read_b64_tr_b16 v[134:135], v9 offset:55296
    v_mfma_f32_16x16x32_bf16 v[160:163], v[36:39], v[112:115], v[160:163]
    v_mfma_f32_16x16x32_bf16 v[148:151], v[80:83], v[116:119], v[148:151]
    ds_read_b64_tr_b16 v[136:137], v10 offset:53248
    v_mfma_f32_16x16x32_bf16 v[20:23], v[84:87], v[116:119], v[20:23]
    ds_read_b64_tr_b16 v[138:139], v10 offset:55296
    v_mfma_f32_16x16x32_bf16 v[164:167], v[36:39], v[116:119], v[164:167]
    s_waitcnt lgkmcnt(7)
    v_mfma_f32_16x16x32_bf16 v[152:155], v[80:83], v[120:123], v[152:155]
    ds_read_b64_tr_b16 v[140:141], v11 offset:53248
    v_mfma_f32_16x16x32_bf16 v[24:27], v[84:87], v[120:123], v[24:27]
    ds_read_b64_tr_b16 v[142:143], v11 offset:55296
    s_barrier
    v_mfma_f32_16x16x32_bf16 v[156:159], v[80:83], v[124:127], v[156:159]
    ds_read_b128 v[36:39], v13 offset:0
    ds_read_b64_tr_b16 v[112:113], v4 offset:0
    v_mfma_f32_16x16x32_bf16 v[28:31], v[84:87], v[124:127], v[28:31]
    ds_read_b64_tr_b16 v[114:115], v4 offset:2048
    s_waitcnt vmcnt(8) lgkmcnt(7)
    v_mfma_f32_16x16x32_bf16 v[144:147], v[88:91], v[128:131], v[144:147]
    buffer_load_dwordx4 v[80:83], v12, s[44:47], s82 offen offset:0 sc1
    ds_read_b64_tr_b16 v[116:117], v5 offset:0
    v_mfma_f32_16x16x32_bf16 v[16:19], v[92:95], v[128:131], v[16:19]
    buffer_load_dwordx4 v[84:87], v252, s[44:47], s82 offen offset:0 sc1
    v_mfma_f32_16x16x32_bf16 v[160:163], v[40:43], v[128:131], v[160:163]
    ds_read_b64_tr_b16 v[118:119], v5 offset:2048
    v_mfma_f32_16x16x32_bf16 v[148:151], v[88:91], v[132:135], v[148:151]
    ds_read_b64_tr_b16 v[120:121], v6 offset:0
    v_mfma_f32_16x16x32_bf16 v[20:23], v[92:95], v[132:135], v[20:23]
    ds_read_b64_tr_b16 v[122:123], v6 offset:2048
    v_mfma_f32_16x16x32_bf16 v[164:167], v[40:43], v[132:135], v[164:167]
    s_waitcnt lgkmcnt(7)
    v_mfma_f32_16x16x32_bf16 v[152:155], v[88:91], v[136:139], v[152:155]
    ds_read_b64_tr_b16 v[124:125], v7 offset:0
    v_mfma_f32_16x16x32_bf16 v[24:27], v[92:95], v[136:139], v[24:27]
    ds_read_b64_tr_b16 v[126:127], v7 offset:2048
    v_mfma_f32_16x16x32_bf16 v[156:159], v[88:91], v[140:143], v[156:159]
    ds_read_b128 v[40:43], v13 offset:1024
    ds_read_b64_tr_b16 v[128:129], v4 offset:4096
    v_mfma_f32_16x16x32_bf16 v[28:31], v[92:95], v[140:143], v[28:31]
    ds_read_b64_tr_b16 v[130:131], v4 offset:6144
    buffer_load_dwordx4 v[88:91], v12, s[44:47], s82 offen offset:1024 sc1
    buffer_load_dwordx4 v[92:95], v252, s[44:47], s82 offen offset:1024 sc1
    s_and_b32 s82, s66, 15
    s_lshr_b64 s[66:67], s[66:67], 4
    s_lshl_b32 s82, s82, 12
    s_waitcnt vmcnt(10) lgkmcnt(7)
    v_mfma_f32_16x16x32_bf16 v[144:147], v[96:99], v[112:115], v[144:147]
    ds_read_b64_tr_b16 v[132:133], v5 offset:4096
    v_mfma_f32_16x16x32_bf16 v[16:19], v[100:103], v[112:115], v[16:19]
    ds_read_b64_tr_b16 v[134:135], v5 offset:6144
    v_mfma_f32_16x16x32_bf16 v[160:163], v[36:39], v[112:115], v[160:163]
    v_mfma_f32_16x16x32_bf16 v[148:151], v[96:99], v[116:119], v[148:151]
    ds_read_b64_tr_b16 v[136:137], v6 offset:4096
    v_mfma_f32_16x16x32_bf16 v[20:23], v[100:103], v[116:119], v[20:23]
    ds_read_b64_tr_b16 v[138:139], v6 offset:6144
    v_mfma_f32_16x16x32_bf16 v[164:167], v[36:39], v[116:119], v[164:167]
    s_waitcnt lgkmcnt(7)
    v_mfma_f32_16x16x32_bf16 v[152:155], v[96:99], v[120:123], v[152:155]
    ds_read_b64_tr_b16 v[140:141], v7 offset:4096
    v_mfma_f32_16x16x32_bf16 v[24:27], v[100:103], v[120:123], v[24:27]
    ds_read_b64_tr_b16 v[142:143], v7 offset:6144
    s_barrier
    v_mfma_f32_16x16x32_bf16 v[156:159], v[96:99], v[124:127], v[156:159]
    ds_read_b128 v[36:39], v13 offset:4096
    ds_read_b64_tr_b16 v[112:113], v4 offset:16384
    v_mfma_f32_16x16x32_bf16 v[28:31], v[100:103], v[124:127], v[28:31]
    ds_read_b64_tr_b16 v[114:115], v4 offset:18432
    s_waitcnt vmcnt(8) lgkmcnt(7)
    v_mfma_f32_16x16x32_bf16 v[144:147], v[104:107], v[128:131], v[144:147]
    buffer_load_dwordx4 v[96:99], v12, s[44:47], s82 offen offset:0 sc1
    ds_read_b64_tr_b16 v[116:117], v5 offset:16384
    v_mfma_f32_16x16x32_bf16 v[16:19], v[108:111], v[128:131], v[16:19]
    buffer_load_dwordx4 v[100:103], v252, s[44:47], s82 offen offset:0 sc1
    v_mfma_f32_16x16x32_bf16 v[160:163], v[40:43], v[128:131], v[160:163]
    ds_read_b64_tr_b16 v[118:119], v5 offset:18432
    v_mfma_f32_16x16x32_bf16 v[148:151], v[104:107], v[132:135], v[148:151]
    ds_read_b64_tr_b16 v[120:121], v6 offset:16384
    v_mfma_f32_16x16x32_bf16 v[20:23], v[108:111], v[132:135], v[20:23]
    ds_read_b64_tr_b16 v[122:123], v6 offset:18432
    v_mfma_f32_16x16x32_bf16 v[164:167], v[40:43], v[132:135], v[164:167]
    s_waitcnt lgkmcnt(7)
    v_mfma_f32_16x16x32_bf16 v[152:155], v[104:107], v[136:139], v[152:155]
    ds_read_b64_tr_b16 v[124:125], v7 offset:16384
    v_mfma_f32_16x16x32_bf16 v[24:27], v[108:111], v[136:139], v[24:27]
    ds_read_b64_tr_b16 v[126:127], v7 offset:18432
    v_mfma_f32_16x16x32_bf16 v[156:159], v[104:107], v[140:143], v[156:159]
    ds_read_b128 v[40:43], v13 offset:5120
    ds_read_b64_tr_b16 v[128:129], v4 offset:20480
    v_mfma_f32_16x16x32_bf16 v[28:31], v[108:111], v[140:143], v[28:31]
    ds_read_b64_tr_b16 v[130:131], v4 offset:22528
    buffer_load_dwordx4 v[104:107], v12, s[44:47], s82 offen offset:1024 sc1
    buffer_load_dwordx4 v[108:111], v252, s[44:47], s82 offen offset:1024 sc1
    s_waitcnt vmcnt(10) lgkmcnt(7)
    v_mfma_f32_16x16x32_bf16 v[144:147], v[64:67], v[112:115], v[144:147]
    ds_read_b64_tr_b16 v[132:133], v5 offset:20480
    v_mfma_f32_16x16x32_bf16 v[16:19], v[68:71], v[112:115], v[16:19]
    ds_read_b64_tr_b16 v[134:135], v5 offset:22528
    v_mfma_f32_16x16x32_bf16 v[160:163], v[36:39], v[112:115], v[160:163]
    v_mfma_f32_16x16x32_bf16 v[148:151], v[64:67], v[116:119], v[148:151]
    v_sub_f32 v56, 1.0, v56
    ds_read_b64_tr_b16 v[136:137], v6 offset:20480
    v_mfma_f32_16x16x32_bf16 v[20:23], v[68:71], v[116:119], v[20:23]
    v_lshlrev_b32 v168, 16, v168
    v_mfma_f32_16x16x32_bf16 v[164:167], v[36:39], v[116:119], v[164:167]
    ds_read_b64_tr_b16 v[138:139], v6 offset:22528
    s_waitcnt lgkmcnt(7)
    v_mfma_f32_16x16x32_bf16 v[152:155], v[64:67], v[120:123], v[152:155]
    v_sub_f32 v57, 1.0, v57
    ds_read_b64_tr_b16 v[140:141], v7 offset:20480
    v_mfma_f32_16x16x32_bf16 v[24:27], v[68:71], v[120:123], v[24:27]
    v_lshlrev_b32 v169, 16, v169
    ds_read_b64_tr_b16 v[142:143], v7 offset:22528
    v_sub_f32 v58, 1.0, v58
    v_lshlrev_b32 v170, 16, v170
    s_barrier
    v_mfma_f32_16x16x32_bf16 v[156:159], v[64:67], v[124:127], v[156:159]
    ds_read_b128 v[36:39], v13 offset:8192
    ds_read_b64_tr_b16 v[114:115], v4 offset:34816
    v_mfma_f32_16x16x32_bf16 v[28:31], v[68:71], v[124:127], v[28:31]
    ds_read_b64_tr_b16 v[112:113], v4 offset:32768
    s_waitcnt vmcnt(8) lgkmcnt(7)
    v_mfma_f32_16x16x32_bf16 v[144:147], v[72:75], v[128:131], v[144:147]
    v_sub_f32 v59, 1.0, v59
    ds_read_b64_tr_b16 v[116:117], v5 offset:32768
    v_mfma_f32_16x16x32_bf16 v[16:19], v[76:79], v[128:131], v[16:19]
    v_lshlrev_b32 v171, 16, v171
    v_mfma_f32_16x16x32_bf16 v[160:163], v[40:43], v[128:131], v[160:163]
    ds_read_b64_tr_b16 v[118:119], v5 offset:34816
    v_mfma_f32_16x16x32_bf16 v[148:151], v[72:75], v[132:135], v[148:151]
    ds_read_b64_tr_b16 v[120:121], v6 offset:32768
    v_mfma_f32_16x16x32_bf16 v[20:23], v[76:79], v[132:135], v[20:23]
    ds_read_b64_tr_b16 v[122:123], v6 offset:34816
    v_mfma_f32_16x16x32_bf16 v[164:167], v[40:43], v[132:135], v[164:167]
    s_waitcnt lgkmcnt(7)
    v_mfma_f32_16x16x32_bf16 v[152:155], v[72:75], v[136:139], v[152:155]
    ds_read_b64_tr_b16 v[124:125], v7 offset:32768
    v_mfma_f32_16x16x32_bf16 v[24:27], v[76:79], v[136:139], v[24:27]
    ds_read_b64_tr_b16 v[126:127], v7 offset:34816
    v_mfma_f32_16x16x32_bf16 v[156:159], v[72:75], v[140:143], v[156:159]
    ds_read_b128 v[40:43], v13 offset:9216
    ds_read_b64_tr_b16 v[128:129], v4 offset:36864
    v_mfma_f32_16x16x32_bf16 v[28:31], v[76:79], v[140:143], v[28:31]
    ds_read_b64_tr_b16 v[130:131], v4 offset:38912
    s_waitcnt vmcnt(6) lgkmcnt(7)
    v_mfma_f32_16x16x32_bf16 v[144:147], v[80:83], v[112:115], v[144:147]
    ds_read_b64_tr_b16 v[132:133], v5 offset:36864
    v_mfma_f32_16x16x32_bf16 v[16:19], v[84:87], v[112:115], v[16:19]
    ds_read_b64_tr_b16 v[134:135], v5 offset:38912
    v_mfma_f32_16x16x32_bf16 v[160:163], v[36:39], v[112:115], v[160:163]
    v_mfma_f32_16x16x32_bf16 v[148:151], v[80:83], v[116:119], v[148:151]
    v_mul_f32 v168, v56, v168
    v_mfma_f32_16x16x32_bf16 v[20:23], v[84:87], v[116:119], v[20:23]
    ds_read_b64_tr_b16 v[136:137], v6 offset:36864
    v_mfma_f32_16x16x32_bf16 v[164:167], v[36:39], v[116:119], v[164:167]
    ds_read_b64_tr_b16 v[138:139], v6 offset:38912
    s_waitcnt lgkmcnt(7)
    v_mfma_f32_16x16x32_bf16 v[152:155], v[80:83], v[120:123], v[152:155]
    v_mul_f32 v169, v57, v169
    ds_read_b64_tr_b16 v[140:141], v7 offset:36864
    v_mfma_f32_16x16x32_bf16 v[24:27], v[84:87], v[120:123], v[24:27]
    ds_read_b64_tr_b16 v[142:143], v7 offset:38912
    v_mul_f32 v170, v58, v170
    s_barrier
    v_mfma_f32_16x16x32_bf16 v[156:159], v[80:83], v[124:127], v[156:159]
    ds_read_b128 v[36:39], v13 offset:12288
    ds_read_b64_tr_b16 v[112:113], v4 offset:49152
    v_mfma_f32_16x16x32_bf16 v[28:31], v[84:87], v[124:127], v[28:31]
    ds_read_b64_tr_b16 v[114:115], v4 offset:51200
    s_waitcnt vmcnt(4) lgkmcnt(7)
    v_mfma_f32_16x16x32_bf16 v[144:147], v[88:91], v[128:131], v[144:147]
    v_mul_f32 v171, v59, v171
    v_mfma_f32_16x16x32_bf16 v[16:19], v[92:95], v[128:131], v[16:19]
    ds_read_b64_tr_b16 v[116:117], v5 offset:49152
    v_mfma_f32_16x16x32_bf16 v[160:163], v[40:43], v[128:131], v[160:163]
    ds_read_b64_tr_b16 v[118:119], v5 offset:51200
    v_mfma_f32_16x16x32_bf16 v[148:151], v[88:91], v[132:135], v[148:151]
    ds_read_b64_tr_b16 v[120:121], v6 offset:49152
    v_mfma_f32_16x16x32_bf16 v[20:23], v[92:95], v[132:135], v[20:23]
    ds_read_b64_tr_b16 v[122:123], v6 offset:51200
    v_mfma_f32_16x16x32_bf16 v[164:167], v[40:43], v[132:135], v[164:167]
    s_waitcnt lgkmcnt(7)
    v_mfma_f32_16x16x32_bf16 v[152:155], v[88:91], v[136:139], v[152:155]
    ds_read_b64_tr_b16 v[124:125], v7 offset:49152
    v_mfma_f32_16x16x32_bf16 v[24:27], v[92:95], v[136:139], v[24:27]
    ds_read_b64_tr_b16 v[126:127], v7 offset:51200
    v_mfma_f32_16x16x32_bf16 v[156:159], v[88:91], v[140:143], v[156:159]
    ds_read_b128 v[40:43], v13 offset:13312
    ds_read_b64_tr_b16 v[128:129], v4 offset:53248
    v_mfma_f32_16x16x32_bf16 v[28:31], v[92:95], v[140:143], v[28:31]
    ds_read_b64_tr_b16 v[130:131], v4 offset:55296
    s_waitcnt vmcnt(2) lgkmcnt(7)
    v_mfma_f32_16x16x32_bf16 v[144:147], v[96:99], v[112:115], v[144:147]
    ds_read_b64_tr_b16 v[132:133], v5 offset:53248
    v_mfma_f32_16x16x32_bf16 v[16:19], v[100:103], v[112:115], v[16:19]
    ds_read_b64_tr_b16 v[134:135], v5 offset:55296
    v_mfma_f32_16x16x32_bf16 v[160:163], v[36:39], v[112:115], v[160:163]
    v_mfma_f32_16x16x32_bf16 v[148:151], v[96:99], v[116:119], v[148:151]
    ds_read_b64_tr_b16 v[136:137], v6 offset:53248
    v_mfma_f32_16x16x32_bf16 v[20:23], v[100:103], v[116:119], v[20:23]
    ds_read_b64_tr_b16 v[138:139], v6 offset:55296
    v_mfma_f32_16x16x32_bf16 v[164:167], v[36:39], v[116:119], v[164:167]
    s_waitcnt lgkmcnt(7)
    v_mfma_f32_16x16x32_bf16 v[152:155], v[96:99], v[120:123], v[152:155]
    ds_read_b64_tr_b16 v[140:141], v7 offset:53248
    v_mfma_f32_16x16x32_bf16 v[24:27], v[100:103], v[120:123], v[24:27]
    ds_read_b64_tr_b16 v[142:143], v7 offset:55296
    s_barrier
    v_mfma_f32_16x16x32_bf16 v[156:159], v[96:99], v[124:127], v[156:159]
    ds_read_b128 v[36:39], v13 offset:16384
    v_mfma_f32_16x16x32_bf16 v[28:31], v[100:103], v[124:127], v[28:31]
    ds_read_b128 v[112:115], v48 offset:0
    s_waitcnt vmcnt(0) lgkmcnt(6)
    v_mfma_f32_16x16x32_bf16 v[144:147], v[104:107], v[128:131], v[144:147]
    ds_read_b128 v[116:119], v49 offset:0
    v_mfma_f32_16x16x32_bf16 v[16:19], v[108:111], v[128:131], v[16:19]
    v_mfma_f32_16x16x32_bf16 v[160:163], v[40:43], v[128:131], v[160:163]
    v_mfma_f32_16x16x32_bf16 v[148:151], v[104:107], v[132:135], v[148:151]
    ds_read_b128 v[120:123], v50 offset:0
    v_mfma_f32_16x16x32_bf16 v[20:23], v[108:111], v[132:135], v[20:23]
    v_mfma_f32_16x16x32_bf16 v[164:167], v[40:43], v[132:135], v[164:167]
    s_waitcnt lgkmcnt(4)
    v_mfma_f32_16x16x32_bf16 v[152:155], v[104:107], v[136:139], v[152:155]
    v_mul_f32 v144, v56, v144
    ds_read_b128 v[124:127], v51 offset:0
    v_mul_f32 v145, v56, v145
    v_mul_f32 v146, v56, v146
    v_mul_f32 v147, v56, v147
    v_mul_f32 v16, v56, v16
    v_mul_f32 v17, v56, v17
    v_mfma_f32_16x16x32_bf16 v[24:27], v[108:111], v[136:139], v[24:27]
    v_mul_f32 v18, v56, v18
    v_mul_f32 v19, v56, v19
    v_mul_f32 v160, v56, v160
    v_mul_f32 v161, v56, v161
    v_mul_f32 v162, v56, v162
    v_mul_f32 v163, v56, v163
    v_mfma_f32_16x16x32_bf16 v[156:159], v[104:107], v[140:143], v[156:159]
    v_mul_f32 v148, v57, v148
    ds_read_b128 v[40:43], v13 offset:17408
    v_mul_f32 v149, v57, v149
    ds_read_b128 v[128:131], v48 offset:1024
    v_mul_f32 v150, v57, v150
    v_mul_f32 v151, v57, v151
    v_mul_f32 v20, v57, v20
    v_mfma_f32_16x16x32_bf16 v[28:31], v[108:111], v[140:143], v[28:31]
    v_mul_f32 v21, v57, v21
    v_mul_f32 v22, v57, v22
    v_mul_f32 v23, v57, v23
    v_mul_f32 v164, v57, v164
    v_mul_f32 v165, v57, v165
    v_mul_f32 v166, v57, v166
    v_mul_f32 v167, v57, v167
    s_nop 3
    v_mul_f32 v152, v58, v152
    v_mul_f32 v153, v58, v153
    v_mul_f32 v154, v58, v154
    v_mul_f32 v155, v58, v155
    v_mul_f32 v24, v58, v24
    v_mul_f32 v25, v58, v25
    v_mul_f32 v26, v58, v26
    v_mul_f32 v27, v58, v27
    s_waitcnt lgkmcnt(4)
    v_mfma_f32_16x16x32_bf16 v[144:147], v[172:175], v[112:115], v[144:147]
    ds_read_b128 v[132:135], v49 offset:1024
    v_mfma_f32_16x16x32_bf16 v[16:19], v[176:179], v[112:115], v[16:19]
    v_mfma_f32_16x16x32_bf16 v[160:163], v[36:39], v[112:115], v[160:163]
    v_mfma_f32_16x16x32_bf16 v[148:151], v[172:175], v[116:119], v[148:151]
    v_mul_f32 v156, v59, v156
    ds_read_b128 v[136:139], v50 offset:1024
    v_mul_f32 v157, v59, v157
    v_mfma_f32_16x16x32_bf16 v[20:23], v[176:179], v[116:119], v[20:23]
    v_mul_f32 v158, v59, v158
    v_mul_f32 v159, v59, v159
    v_mul_f32 v28, v59, v28
    v_mfma_f32_16x16x32_bf16 v[164:167], v[36:39], v[116:119], v[164:167]
    v_mul_f32 v29, v59, v29
    v_mul_f32 v30, v59, v30
    v_mul_f32 v31, v59, v31
    s_waitcnt lgkmcnt(4)
    v_mfma_f32_16x16x32_bf16 v[152:155], v[172:175], v[120:123], v[152:155]
    ds_read_b128 v[140:143], v51 offset:1024
    v_mfma_f32_16x16x32_bf16 v[24:27], v[176:179], v[120:123], v[24:27]
    s_barrier
    v_mfma_f32_16x16x32_bf16 v[156:159], v[172:175], v[124:127], v[156:159]
    ds_read_b128 v[36:39], v13 offset:20480
    v_mfma_f32_16x16x32_bf16 v[28:31], v[176:179], v[124:127], v[28:31]
    ds_read_b128 v[112:115], v48 offset:16384
    s_waitcnt lgkmcnt(4)
    v_mfma_f32_16x16x32_bf16 v[144:147], v[180:183], v[128:131], v[144:147]
    ds_read_b128 v[116:119], v49 offset:16384
    v_mfma_f32_16x16x32_bf16 v[16:19], v[184:187], v[128:131], v[16:19]
    v_mfma_f32_16x16x32_bf16 v[160:163], v[40:43], v[128:131], v[160:163]
    v_mfma_f32_16x16x32_bf16 v[148:151], v[180:183], v[132:135], v[148:151]
    ds_read_b128 v[120:123], v50 offset:16384
    v_mfma_f32_16x16x32_bf16 v[20:23], v[184:187], v[132:135], v[20:23]
    v_mfma_f32_16x16x32_bf16 v[164:167], v[40:43], v[132:135], v[164:167]
    s_waitcnt lgkmcnt(4)
    v_mfma_f32_16x16x32_bf16 v[152:155], v[180:183], v[136:139], v[152:155]
    ds_read_b128 v[124:127], v51 offset:16384
    v_mfma_f32_16x16x32_bf16 v[24:27], v[184:187], v[136:139], v[24:27]
    v_mfma_f32_16x16x32_bf16 v[156:159], v[180:183], v[140:143], v[156:159]
    ds_read_b128 v[40:43], v13 offset:21504
    v_mfma_f32_16x16x32_bf16 v[28:31], v[184:187], v[140:143], v[28:31]
    ds_read_b128 v[128:131], v48 offset:17408
    s_waitcnt lgkmcnt(4)
    v_mfma_f32_16x16x32_bf16 v[144:147], v[188:191], v[112:115], v[144:147]
    ds_read_b128 v[132:135], v49 offset:17408
    v_mfma_f32_16x16x32_bf16 v[16:19], v[192:195], v[112:115], v[16:19]
    v_mfma_f32_16x16x32_bf16 v[160:163], v[36:39], v[112:115], v[160:163]
    v_mfma_f32_16x16x32_bf16 v[148:151], v[188:191], v[116:119], v[148:151]
    ds_read_b128 v[136:139], v50 offset:17408
    v_mfma_f32_16x16x32_bf16 v[20:23], v[192:195], v[116:119], v[20:23]
    v_mfma_f32_16x16x32_bf16 v[164:167], v[36:39], v[116:119], v[164:167]
    s_waitcnt lgkmcnt(4)
    v_mfma_f32_16x16x32_bf16 v[152:155], v[188:191], v[120:123], v[152:155]
    ds_read_b128 v[140:143], v51 offset:17408
    v_mfma_f32_16x16x32_bf16 v[24:27], v[192:195], v[120:123], v[24:27]
    s_barrier
    v_mfma_f32_16x16x32_bf16 v[156:159], v[188:191], v[124:127], v[156:159]
    ds_read_b128 v[36:39], v13 offset:24576
    v_mfma_f32_16x16x32_bf16 v[28:31], v[192:195], v[124:127], v[28:31]
    ds_read_b128 v[112:115], v48 offset:32768
    s_waitcnt lgkmcnt(4)
    v_mfma_f32_16x16x32_bf16 v[144:147], v[196:199], v[128:131], v[144:147]
    ds_read_b128 v[116:119], v49 offset:32768
    v_mfma_f32_16x16x32_bf16 v[16:19], v[200:203], v[128:131], v[16:19]
    v_mfma_f32_16x16x32_bf16 v[160:163], v[40:43], v[128:131], v[160:163]
    v_mfma_f32_16x16x32_bf16 v[148:151], v[196:199], v[132:135], v[148:151]
    ds_read_b128 v[120:123], v50 offset:32768
    v_mfma_f32_16x16x32_bf16 v[20:23], v[200:203], v[132:135], v[20:23]
    v_mfma_f32_16x16x32_bf16 v[164:167], v[40:43], v[132:135], v[164:167]
    s_waitcnt lgkmcnt(4)
    v_mfma_f32_16x16x32_bf16 v[152:155], v[196:199], v[136:139], v[152:155]
    ds_read_b128 v[124:127], v51 offset:32768
    v_mfma_f32_16x16x32_bf16 v[24:27], v[200:203], v[136:139], v[24:27]
    v_mfma_f32_16x16x32_bf16 v[156:159], v[196:199], v[140:143], v[156:159]
    ds_read_b128 v[40:43], v13 offset:25600
    v_mfma_f32_16x16x32_bf16 v[28:31], v[200:203], v[140:143], v[28:31]
    ds_read_b128 v[128:131], v48 offset:33792
    s_waitcnt lgkmcnt(4)
    v_mfma_f32_16x16x32_bf16 v[144:147], v[204:207], v[112:115], v[144:147]
    ds_read_b128 v[132:135], v49 offset:33792
    v_mfma_f32_16x16x32_bf16 v[16:19], v[208:211], v[112:115], v[16:19]
    v_mfma_f32_16x16x32_bf16 v[160:163], v[36:39], v[112:115], v[160:163]
    v_mfma_f32_16x16x32_bf16 v[148:151], v[204:207], v[116:119], v[148:151]
    ds_read_b128 v[136:139], v50 offset:33792
    v_mfma_f32_16x16x32_bf16 v[20:23], v[208:211], v[116:119], v[20:23]
    v_mfma_f32_16x16x32_bf16 v[164:167], v[36:39], v[116:119], v[164:167]
    s_waitcnt lgkmcnt(4)
    v_mfma_f32_16x16x32_bf16 v[152:155], v[204:207], v[120:123], v[152:155]
    ds_read_b128 v[140:143], v51 offset:33792
    v_mfma_f32_16x16x32_bf16 v[24:27], v[208:211], v[120:123], v[24:27]
    s_barrier
    v_mfma_f32_16x16x32_bf16 v[156:159], v[204:207], v[124:127], v[156:159]
    ds_read_b128 v[36:39], v13 offset:28672
    v_mfma_f32_16x16x32_bf16 v[28:31], v[208:211], v[124:127], v[28:31]
    ds_read_b128 v[112:115], v48 offset:49152
    s_waitcnt lgkmcnt(4)
    v_mfma_f32_16x16x32_bf16 v[144:147], v[212:215], v[128:131], v[144:147]
    ds_read_b128 v[116:119], v49 offset:49152
    v_mfma_f32_16x16x32_bf16 v[16:19], v[216:219], v[128:131], v[16:19]
    v_mfma_f32_16x16x32_bf16 v[160:163], v[40:43], v[128:131], v[160:163]
    v_mfma_f32_16x16x32_bf16 v[148:151], v[212:215], v[132:135], v[148:151]
    ds_read_b128 v[120:123], v50 offset:49152
    v_mfma_f32_16x16x32_bf16 v[20:23], v[216:219], v[132:135], v[20:23]
    v_mfma_f32_16x16x32_bf16 v[164:167], v[40:43], v[132:135], v[164:167]
    s_waitcnt lgkmcnt(4)
    v_mfma_f32_16x16x32_bf16 v[152:155], v[212:215], v[136:139], v[152:155]
    ds_read_b128 v[124:127], v51 offset:49152
    v_mfma_f32_16x16x32_bf16 v[24:27], v[216:219], v[136:139], v[24:27]
    v_mfma_f32_16x16x32_bf16 v[156:159], v[212:215], v[140:143], v[156:159]
    ds_read_b128 v[40:43], v13 offset:29696
    v_mfma_f32_16x16x32_bf16 v[28:31], v[216:219], v[140:143], v[28:31]
    ds_read_b128 v[128:131], v48 offset:50176
    s_waitcnt lgkmcnt(4)
    v_mfma_f32_16x16x32_bf16 v[144:147], v[220:223], v[112:115], v[144:147]
    ds_read_b128 v[132:135], v49 offset:50176
    v_mfma_f32_16x16x32_bf16 v[16:19], v[224:227], v[112:115], v[16:19]
    v_mfma_f32_16x16x32_bf16 v[160:163], v[36:39], v[112:115], v[160:163]
    v_mfma_f32_16x16x32_bf16 v[148:151], v[220:223], v[116:119], v[148:151]
    ds_read_b128 v[136:139], v50 offset:50176
    v_mfma_f32_16x16x32_bf16 v[20:23], v[224:227], v[116:119], v[20:23]
    v_mfma_f32_16x16x32_bf16 v[164:167], v[36:39], v[116:119], v[164:167]
    s_waitcnt lgkmcnt(4)
    v_mfma_f32_16x16x32_bf16 v[152:155], v[220:223], v[120:123], v[152:155]
    ds_read_b128 v[140:143], v51 offset:50176
    v_mfma_f32_16x16x32_bf16 v[24:27], v[224:227], v[120:123], v[24:27]
    s_and_b32 s60, s29, 1
    s_lshl_b32 s60, s60, 10
    s_xor_b32 s61, s29, 1
    s_mul_i32 s61, s61, 5120
    s_add_u32 s61, s61, 65536
    v_lshlrev_b32 v2, 4, v1
    s_barrier
    v_mfma_f32_16x16x32_bf16 v[156:159], v[220:223], v[124:127], v[156:159]
    ds_read_b128 v[36:39], v13 offset:0
    ds_read_b64 v[112:113], v52 offset:0
    v_mfma_f32_16x16x32_bf16 v[28:31], v[224:227], v[124:127], v[28:31]
    ds_read_b64 v[114:115], v52 offset:512
    s_waitcnt lgkmcnt(5)
    v_mfma_f32_16x16x32_bf16 v[144:147], v[228:231], v[128:131], v[144:147]
    v_add_u32 v3, s61, v2
    ds_read_b64 v[116:117], v53 offset:0
    v_mfma_f32_16x16x32_bf16 v[16:19], v[232:235], v[128:131], v[16:19]
    s_mul_i32 s61, s29, 5120
    ds_read_b64 v[118:119], v53 offset:512
    v_mfma_f32_16x16x32_bf16 v[160:163], v[40:43], v[128:131], v[160:163]
    s_add_u32 s61, s61, 65536
    v_add_u32 v2, s61, v2
    v_mfma_f32_16x16x32_bf16 v[148:151], v[228:231], v[132:135], v[148:151]
    ds_read_b64 v[120:121], v54 offset:0
    v_mfma_f32_16x16x32_bf16 v[20:23], v[232:235], v[132:135], v[20:23]
    ds_read_b64 v[122:123], v54 offset:512
    v_mfma_f32_16x16x32_bf16 v[164:167], v[40:43], v[132:135], v[164:167]
    s_waitcnt lgkmcnt(7)
    v_mfma_f32_16x16x32_bf16 v[152:155], v[228:231], v[136:139], v[152:155]
    ds_read_b64 v[124:125], v55 offset:0
    v_mfma_f32_16x16x32_bf16 v[24:27], v[232:235], v[136:139], v[24:27]
    ds_read_b64 v[126:127], v55 offset:512
    v_mfma_f32_16x16x32_bf16 v[156:159], v[228:231], v[140:143], v[156:159]
    ds_read_b128 v[40:43], v13 offset:1024
    ds_read_b64 v[128:129], v52 offset:1024
    v_mfma_f32_16x16x32_bf16 v[28:31], v[232:235], v[140:143], v[28:31]
    ds_read_b64 v[130:131], v52 offset:1536
    s_waitcnt lgkmcnt(7)
    v_mfma_f32_16x16x32_bf16 v[144:147], v[236:239], v[112:115], v[144:147]
    ds_read_b64 v[132:133], v53 offset:1024
    v_mfma_f32_16x16x32_bf16 v[16:19], v[240:243], v[112:115], v[16:19]
    ds_read_b64 v[134:135], v53 offset:1536
    v_mfma_f32_16x16x32_bf16 v[160:163], v[36:39], v[112:115], v[160:163]
    v_mfma_f32_16x16x32_bf16 v[148:151], v[236:239], v[116:119], v[148:151]
    ds_read_b64 v[136:137], v54 offset:1024
    v_mfma_f32_16x16x32_bf16 v[20:23], v[240:243], v[116:119], v[20:23]
    ds_read_b64 v[138:139], v54 offset:1536
    v_mfma_f32_16x16x32_bf16 v[164:167], v[36:39], v[116:119], v[164:167]
    s_waitcnt lgkmcnt(7)
    v_mfma_f32_16x16x32_bf16 v[152:155], v[236:239], v[120:123], v[152:155]
    ds_read_b64 v[140:141], v55 offset:1024
    v_mfma_f32_16x16x32_bf16 v[24:27], v[240:243], v[120:123], v[24:27]
    ds_read_b64 v[142:143], v55 offset:1536
    v_mfma_f32_16x16x32_bf16 v[156:159], v[236:239], v[124:127], v[156:159]
    v_mfma_f32_16x16x32_bf16 v[28:31], v[240:243], v[124:127], v[28:31]
    s_waitcnt lgkmcnt(4)
    v_mfma_f32_16x16x32_bf16 v[16:19], v[248:251], v[128:131], v[16:19]
    v_mfma_f32_16x16x32_bf16 v[20:23], v[248:251], v[132:135], v[20:23]
    v_mfma_f32_16x16x32_bf16 v[164:167], v[40:43], v[132:135], v[164:167]
    s_waitcnt lgkmcnt(0)
    v_mfma_f32_16x16x32_bf16 v[24:27], v[248:251], v[136:139], v[24:27]
    v_mfma_f32_16x16x32_bf16 v[28:31], v[248:251], v[140:143], v[28:31]
    v_mfma_f32_16x16x32_bf16 v[144:147], v[244:247], v[128:131], v[144:147]
    v_and_b32 v4, 15, v1
    v_mul_u32_u24 v4, 1280, v4
    v_mfma_f32_16x16x32_bf16 v[160:163], v[40:43], v[128:131], v[160:163]
    v_lshrrev_b32 v5, 4, v1
    v_lshl_add_u32 v4, v5, 3, v4
    ds_write_b128 v3, v[16:19] offset:1024
    v_mfma_f32_16x16x32_bf16 v[148:151], v[244:247], v[132:135], v[148:151]
    s_mul_i32 s80, s76, 81920
    s_lshl_b32 s61, s83, 5
    ds_write_b128 v3, v[20:23] offset:0
    v_mfma_f32_16x16x32_bf16 v[152:155], v[244:247], v[136:139], v[152:155]
    s_add_u32 s81, s80, s61
    s_mul_i32 s61, s77, 160
    ds_write_b128 v3, v[164:167] offset:4096
    v_mfma_f32_16x16x32_bf16 v[156:159], v[244:247], v[140:143], v[156:159]
    s_add_u32 s80, s80, s61
    s_add_u32 s80, s80, 128
    ds_write_b128 v3, v[24:27] offset:3072
    ds_write_b128 v3, v[28:31] offset:2048
    s_waitcnt lgkmcnt(0)
    s_barrier
    ds_read_b128 v[64:67], v2 offset:0
    ds_read_b128 v[68:71], v2 offset:1024
    ds_read_b128 v[72:75], v2 offset:2048
    ds_read_b128 v[76:79], v2 offset:3072
    ds_read_b128 v[80:83], v2 offset:4096
    v_add_f32 v144, v168, v144
    v_add_f32 v145, v168, v145
    v_add_f32 v146, v168, v146
    v_add_f32 v147, v168, v147
    v_add_f32 v148, v169, v148
    v_add_f32 v149, v169, v149
    v_add_f32 v150, v169, v150
    v_add_f32 v151, v169, v151
    v_add_f32 v152, v170, v152
    v_add_f32 v153, v170, v153
    v_add_f32 v154, v170, v154
    v_add_f32 v155, v170, v155
    v_add_f32 v156, v171, v156
    v_add_f32 v157, v171, v157
    v_add_f32 v158, v171, v158
    v_add_f32 v159, v171, v159
    v_add_f32 v160, v168, v160
    v_add_f32 v161, v168, v161
    v_add_f32 v162, v168, v162
    v_add_f32 v163, v168, v163
    s_mul_i32 s60, s72, 20480
    s_add_u32 s60, s60, s81
    s_waitcnt lgkmcnt(4)
    v_pk_add_f32 v[144:145], v[144:145], v[64:65]
    v_pk_add_f32 v[146:147], v[146:147], v[66:67]
    v_cvt_pk_bf16_f32 v144, v144, v145
    v_cvt_pk_bf16_f32 v145, v146, v147
    buffer_store_dwordx2 v[144:145], v4, s[56:59], s60 offen
    s_mul_i32 s60, s73, 20480
    s_add_u32 s60, s60, s81
    s_waitcnt lgkmcnt(3)
    v_pk_add_f32 v[148:149], v[148:149], v[68:69]
    v_pk_add_f32 v[150:151], v[150:151], v[70:71]
    v_cvt_pk_bf16_f32 v148, v148, v149
    v_cvt_pk_bf16_f32 v149, v150, v151
    buffer_store_dwordx2 v[148:149], v4, s[56:59], s60 offen
    s_mul_i32 s60, s74, 20480
    s_add_u32 s60, s60, s81
    s_waitcnt lgkmcnt(2)
    v_pk_add_f32 v[152:153], v[152:153], v[72:73]
    v_pk_add_f32 v[154:155], v[154:155], v[74:75]
    v_cvt_pk_bf16_f32 v152, v152, v153
    v_cvt_pk_bf16_f32 v153, v154, v155
    buffer_store_dwordx2 v[152:153], v4, s[56:59], s60 offen
    s_mul_i32 s60, s75, 20480
    s_add_u32 s60, s60, s81
    s_waitcnt lgkmcnt(1)
    v_pk_add_f32 v[156:157], v[156:157], v[76:77]
    v_pk_add_f32 v[158:159], v[158:159], v[78:79]
    v_cvt_pk_bf16_f32 v156, v156, v157
    v_cvt_pk_bf16_f32 v157, v158, v159
    buffer_store_dwordx2 v[156:157], v4, s[56:59], s60 offen
    s_mul_i32 s60, s72, 20480
    s_add_u32 s60, s60, s80
    s_waitcnt lgkmcnt(0)
    v_pk_add_f32 v[160:161], v[160:161], v[80:81]
    v_pk_add_f32 v[162:163], v[162:163], v[82:83]
    v_cvt_pk_bf16_f32 v160, v160, v161
    v_cvt_pk_bf16_f32 v161, v162, v163
    buffer_store_dwordx2 v[160:161], v4, s[56:59], s60 offen
    s_or_b32 s60, s2, s29
    s_cmp_lg_u32 s60, 0
    s_cbranch_scc1 L_end
    s_mov_b32 s60, 0
    v_mov_b32 v4, s28
    v_mov_b32 v5, 0
    s_mov_b64 exec, 1
    buffer_store_dword v4, v5, s[32:35], s60 offen sc1
    s_mov_b64 exec, -1
    s_branch L_end
L_F_u4:
    v_lshlrev_b32 v12, 4, v1
    s_mul_i32 s82, s77, 348160
    s_add_u32 s82, s82, 3948544
    s_lshl_b32 s79, s77, 1
    s_add_u32 s79, s79, s76
    s_and_b32 s79, s79, 7
    s_mov_b32 s66, 0x76543210
    s_mov_b32 s67, 0xba98
    s_cmp_eq_u32 s79, 0
    s_cselect_b32 s66, 0x76543102, s66
    s_cselect_b32 s67, 0xb98a, s67
    s_cmp_eq_u32 s79, 1
    s_cselect_b32 s66, 0x76542130, s66
    s_cselect_b32 s67, 0xa9b8, s67
    s_cmp_eq_u32 s79, 2
    s_cselect_b32 s66, 0x76532410, s66
    s_cselect_b32 s67, 0xba98, s67
    s_cmp_eq_u32 s79, 3
    s_cselect_b32 s66, 0x76435210, s66
    s_cselect_b32 s67, 0xba98, s67
    s_cmp_eq_u32 s79, 4
    s_cselect_b32 s66, 0x75463210, s66
    s_cselect_b32 s67, 0xba98, s67
    s_cmp_eq_u32 s79, 5
    s_cselect_b32 s66, 0x65743210, s66
    s_cselect_b32 s67, 0xba98, s67
    s_cmp_eq_u32 s79, 6
    s_cselect_b32 s66, 0x68543210, s66
    s_cselect_b32 s67, 0xba97, s67
    s_cmp_eq_u32 s79, 7
    s_cselect_b32 s66, 0x96543210, s66
    s_cselect_b32 s67, 0xba87, s67
    s_cmp_eq_u32 s95, 1
    s_cbranch_scc1 Lf0_22
    s_barrier
Lf0_22:
    s_barrier
    s_and_b32 s60, s66, 15
    s_lshr_b64 s[66:67], s[66:67], 4
    s_lshl_b32 s60, s60, 12
    s_mov_b32 m0, 0x20000
    s_add_u32 s60, s60, s82
    buffer_load_dwordx4 v12, s[32:35], s60 offen offset:0 sc1 lds
    buffer_load_dwordx4 v12, s[32:35], s60 offen offset:1024 sc1 lds
    buffer_load_dwordx4 v12, s[32:35], s60 offen offset:2048 sc1 lds
    buffer_load_dwordx4 v12, s[32:35], s60 offen offset:3072 sc1 lds
    s_and_b32 s60, s66, 15
    s_lshr_b64 s[66:67], s[66:67], 4
    s_lshl_b32 s60, s60, 12
    s_mov_b32 m0, 0x21000
    s_add_u32 s60, s60, s82
    buffer_load_dwordx4 v12, s[32:35], s60 offen offset:0 sc1 lds
    buffer_load_dwordx4 v12, s[32:35], s60 offen offset:1024 sc1 lds
    buffer_load_dwordx4 v12, s[32:35], s60 offen offset:2048 sc1 lds
    buffer_load_dwordx4 v12, s[32:35], s60 offen offset:3072 sc1 lds
    s_waitcnt vmcnt(4)
    s_barrier
    s_and_b32 s60, s66, 15
    s_lshr_b64 s[66:67], s[66:67], 4
    s_lshl_b32 s60, s60, 12
    s_mov_b32 m0, 0x22000
    s_add_u32 s60, s60, s82
    buffer_load_dwordx4 v12, s[32:35], s60 offen offset:0 sc1 lds
    buffer_load_dwordx4 v12, s[32:35], s60 offen offset:1024 sc1 lds
    buffer_load_dwordx4 v12, s[32:35], s60 offen offset:2048 sc1 lds
    buffer_load_dwordx4 v12, s[32:35], s60 offen offset:3072 sc1 lds
    s_and_b32 s60, s66, 15
    s_lshr_b64 s[66:67], s[66:67], 4
    s_lshl_b32 s60, s60, 12
    s_mov_b32 m0, 0x23000
    s_add_u32 s60, s60, s82
    buffer_load_dwordx4 v12, s[32:35], s60 offen offset:0 sc1 lds
    buffer_load_dwordx4 v12, s[32:35], s60 offen offset:1024 sc1 lds
    buffer_load_dwordx4 v12, s[32:35], s60 offen offset:2048 sc1 lds
    buffer_load_dwordx4 v12, s[32:35], s60 offen offset:3072 sc1 lds
    s_and_b32 s60, s66, 15
    s_lshr_b64 s[66:67], s[66:67], 4
    s_lshl_b32 s60, s60, 12
    s_mov_b32 m0, 0x24000
    s_add_u32 s60, s60, s82
    buffer_load_dwordx4 v12, s[32:35], s60 offen offset:0 sc1 lds
    buffer_load_dwordx4 v12, s[32:35], s60 offen offset:1024 sc1 lds
    buffer_load_dwordx4 v12, s[32:35], s60 offen offset:2048 sc1 lds
    buffer_load_dwordx4 v12, s[32:35], s60 offen offset:3072 sc1 lds
    s_and_b32 s60, s66, 15
    s_lshr_b64 s[66:67], s[66:67], 4
    s_lshl_b32 s60, s60, 12
    s_mov_b32 m0, 0x25000
    s_add_u32 s60, s60, s82
    buffer_load_dwordx4 v12, s[32:35], s60 offen offset:0 sc1 lds
    buffer_load_dwordx4 v12, s[32:35], s60 offen offset:1024 sc1 lds
    buffer_load_dwordx4 v12, s[32:35], s60 offen offset:2048 sc1 lds
    buffer_load_dwordx4 v12, s[32:35], s60 offen offset:3072 sc1 lds
    s_and_b32 s60, s66, 15
    s_lshr_b64 s[66:67], s[66:67], 4
    s_lshl_b32 s60, s60, 12
    s_mov_b32 m0, 0x26000
    s_add_u32 s60, s60, s82
    buffer_load_dwordx4 v12, s[32:35], s60 offen offset:0 sc1 lds
    buffer_load_dwordx4 v12, s[32:35], s60 offen offset:1024 sc1 lds
    buffer_load_dwordx4 v12, s[32:35], s60 offen offset:2048 sc1 lds
    buffer_load_dwordx4 v12, s[32:35], s60 offen offset:3072 sc1 lds
    s_and_b32 s60, s66, 15
    s_lshr_b64 s[66:67], s[66:67], 4
    s_lshl_b32 s60, s60, 12
    s_mov_b32 m0, 0x27000
    s_add_u32 s60, s60, s82
    buffer_load_dwordx4 v12, s[32:35], s60 offen offset:0 sc1 lds
    buffer_load_dwordx4 v12, s[32:35], s60 offen offset:1024 sc1 lds
    buffer_load_dwordx4 v12, s[32:35], s60 offen offset:2048 sc1 lds
    buffer_load_dwordx4 v12, s[32:35], s60 offen offset:3072 sc1 lds
    s_waitcnt vmcnt(24)
    s_barrier
    s_waitcnt vmcnt(20)
    s_barrier
    s_and_b32 s60, s66, 15
    s_lshr_b64 s[66:67], s[66:67], 4
    s_lshl_b32 s60, s60, 12
    s_mov_b32 m0, 0x20000
    s_add_u32 s60, s60, s82
    buffer_load_dwordx4 v12, s[32:35], s60 offen offset:0 sc1 lds
    buffer_load_dwordx4 v12, s[32:35], s60 offen offset:1024 sc1 lds
    buffer_load_dwordx4 v12, s[32:35], s60 offen offset:2048 sc1 lds
    buffer_load_dwordx4 v12, s[32:35], s60 offen offset:3072 sc1 lds
    s_waitcnt vmcnt(20)
    s_barrier
    s_and_b32 s60, s66, 15
    s_lshr_b64 s[66:67], s[66:67], 4
    s_lshl_b32 s60, s60, 12
    s_mov_b32 m0, 0x21000
    s_add_u32 s60, s60, s82
    buffer_load_dwordx4 v12, s[32:35], s60 offen offset:0 sc1 lds
    buffer_load_dwordx4 v12, s[32:35], s60 offen offset:1024 sc1 lds
    buffer_load_dwordx4 v12, s[32:35], s60 offen offset:2048 sc1 lds
    buffer_load_dwordx4 v12, s[32:35], s60 offen offset:3072 sc1 lds
    s_waitcnt vmcnt(20)
    s_barrier
    s_and_b32 s60, s66, 15
    s_lshr_b64 s[66:67], s[66:67], 4
    s_lshl_b32 s60, s60, 12
    s_mov_b32 m0, 0x22000
    s_add_u32 s60, s60, s82
    buffer_load_dwordx4 v12, s[32:35], s60 offen offset:0 sc1 lds
    buffer_load_dwordx4 v12, s[32:35], s60 offen offset:1024 sc1 lds
    buffer_load_dwordx4 v12, s[32:35], s60 offen offset:2048 sc1 lds
    buffer_load_dwordx4 v12, s[32:35], s60 offen offset:3072 sc1 lds
    s_waitcnt vmcnt(20)
    s_barrier
    s_and_b32 s60, s66, 15
    s_lshr_b64 s[66:67], s[66:67], 4
    s_lshl_b32 s60, s60, 12
    s_mov_b32 m0, 0x23000
    s_add_u32 s60, s60, s82
    buffer_load_dwordx4 v12, s[32:35], s60 offen offset:0 sc1 lds
    buffer_load_dwordx4 v12, s[32:35], s60 offen offset:1024 sc1 lds
    buffer_load_dwordx4 v12, s[32:35], s60 offen offset:2048 sc1 lds
    buffer_load_dwordx4 v12, s[32:35], s60 offen offset:3072 sc1 lds
    s_waitcnt vmcnt(20)
    s_barrier
    s_mov_b32 m0, 0x24000
    s_add_u32 s60, s82, 49152
    buffer_load_dwordx4 v12, s[32:35], s60 offen offset:0 sc1 lds
    buffer_load_dwordx4 v12, s[32:35], s60 offen offset:1024 sc1 lds
    buffer_load_dwordx4 v12, s[32:35], s60 offen offset:2048 sc1 lds
    buffer_load_dwordx4 v12, s[32:35], s60 offen offset:3072 sc1 lds
    s_waitcnt vmcnt(20)
    s_barrier
    s_mov_b32 m0, 0x25000
    s_add_u32 s60, s82, 53248
    buffer_load_dwordx4 v12, s[32:35], s60 offen offset:0 sc1 lds
    buffer_load_dwordx4 v12, s[32:35], s60 offen offset:1024 sc1 lds
    buffer_load_dwordx4 v12, s[32:35], s60 offen offset:2048 sc1 lds
    buffer_load_dwordx4 v12, s[32:35], s60 offen offset:3072 sc1 lds
    s_waitcnt vmcnt(20)
    s_barrier
    s_mov_b32 m0, 0x26000
    s_add_u32 s60, s82, 57344
    buffer_load_dwordx4 v12, s[32:35], s60 offen offset:0 sc1 lds
    buffer_load_dwordx4 v12, s[32:35], s60 offen offset:1024 sc1 lds
    buffer_load_dwordx4 v12, s[32:35], s60 offen offset:2048 sc1 lds
    buffer_load_dwordx4 v12, s[32:35], s60 offen offset:3072 sc1 lds
    s_waitcnt vmcnt(20)
    s_barrier
    s_mov_b32 m0, 0x27000
    s_add_u32 s60, s82, 61440
    buffer_load_dwordx4 v12, s[32:35], s60 offen offset:0 sc1 lds
    buffer_load_dwordx4 v12, s[32:35], s60 offen offset:1024 sc1 lds
    buffer_load_dwordx4 v12, s[32:35], s60 offen offset:2048 sc1 lds
    buffer_load_dwordx4 v12, s[32:35], s60 offen offset:3072 sc1 lds
    s_waitcnt vmcnt(20)
    s_barrier
    s_mov_b32 m0, 0x20000
    s_add_u32 s60, s82, 65536
    buffer_load_dwordx4 v12, s[32:35], s60 offen offset:0 sc1 lds
    buffer_load_dwordx4 v12, s[32:35], s60 offen offset:1024 sc1 lds
    buffer_load_dwordx4 v12, s[32:35], s60 offen offset:2048 sc1 lds
    buffer_load_dwordx4 v12, s[32:35], s60 offen offset:3072 sc1 lds
    s_waitcnt vmcnt(20)
    s_barrier
    s_waitcnt vmcnt(16)
    s_barrier
    s_waitcnt vmcnt(12)
    s_barrier
    s_waitcnt vmcnt(8)
    s_barrier
    s_waitcnt vmcnt(4)
    s_barrier
    s_waitcnt vmcnt(0)
    s_barrier
    s_branch L_end
L_F_loader:
    v_lshlrev_b32 v12, 4, v1
    s_cmp_eq_u32 s95, 1
    s_cbranch_scc1 Lf0_23
    s_barrier
Lf0_23:
    s_barrier
    s_sub_u32 s60, s29, 5
    s_lshl_b32 s60, s60, 1
    s_lshl_b32 s61, s76, 2
    s_add_u32 s61, s61, s60
    s_mul_i32 s82, s61, 20480
    s_add_u32 s82, s82, 6553600
    s_lshl_b32 s83, s60, 12
    s_waitcnt vmcnt(56)
    s_barrier
    s_waitcnt vmcnt(48)
    s_barrier
    s_waitcnt vmcnt(40)
    s_barrier
    s_and_b32 s90, s66, 15
    s_lshr_b64 s[66:67], s[66:67], 4
    s_lshl_b32 s90, s90, 19
    s_add_u32 s90, s90, s80
    s_add_u32 m0, s81, 0
    s_add_u32 s60, s90, 0
    buffer_load_dwordx4 v240, s[48:51], s60 offen offset:0 lds
    buffer_load_dwordx4 v241, s[48:51], s60 offen offset:1024 lds
    buffer_load_dwordx4 v242, s[48:51], s60 offen offset:2048 lds
    buffer_load_dwordx4 v243, s[48:51], s60 offen offset:3072 lds
    s_waitcnt vmcnt(36)
    s_barrier
    s_add_u32 m0, s81, 4096
    s_add_u32 s60, s90, 131072
    buffer_load_dwordx4 v240, s[48:51], s60 offen offset:0 lds
    buffer_load_dwordx4 v241, s[48:51], s60 offen offset:1024 lds
    buffer_load_dwordx4 v242, s[48:51], s60 offen offset:2048 lds
    buffer_load_dwordx4 v243, s[48:51], s60 offen offset:3072 lds
    s_add_u32 s81, s81, 16384
    s_waitcnt vmcnt(32)
    s_barrier
    s_and_b32 s90, s66, 15
    s_lshr_b64 s[66:67], s[66:67], 4
    s_lshl_b32 s90, s90, 19
    s_add_u32 s90, s90, s80
    s_add_u32 m0, s81, 0
    s_add_u32 s60, s90, 0
    buffer_load_dwordx4 v240, s[48:51], s60 offen offset:0 lds
    buffer_load_dwordx4 v241, s[48:51], s60 offen offset:1024 lds
    buffer_load_dwordx4 v242, s[48:51], s60 offen offset:2048 lds
    buffer_load_dwordx4 v243, s[48:51], s60 offen offset:3072 lds
    s_waitcnt vmcnt(28)
    s_barrier
    s_add_u32 m0, s81, 4096
    s_add_u32 s60, s90, 131072
    buffer_load_dwordx4 v240, s[48:51], s60 offen offset:0 lds
    buffer_load_dwordx4 v241, s[48:51], s60 offen offset:1024 lds
    buffer_load_dwordx4 v242, s[48:51], s60 offen offset:2048 lds
    buffer_load_dwordx4 v243, s[48:51], s60 offen offset:3072 lds
    s_add_u32 s81, s81, 16384
    s_waitcnt vmcnt(24)
    s_barrier
    s_and_b32 s90, s66, 15
    s_lshr_b64 s[66:67], s[66:67], 4
    s_lshl_b32 s90, s90, 19
    s_add_u32 s90, s90, s80
    s_add_u32 m0, s81, 0
    s_add_u32 s60, s90, 0
    buffer_load_dwordx4 v240, s[48:51], s60 offen offset:0 lds
    buffer_load_dwordx4 v241, s[48:51], s60 offen offset:1024 lds
    buffer_load_dwordx4 v242, s[48:51], s60 offen offset:2048 lds
    buffer_load_dwordx4 v243, s[48:51], s60 offen offset:3072 lds
    s_waitcnt vmcnt(20)
    s_barrier
    s_add_u32 m0, s81, 4096
    s_add_u32 s60, s90, 131072
    buffer_load_dwordx4 v240, s[48:51], s60 offen offset:0 lds
    buffer_load_dwordx4 v241, s[48:51], s60 offen offset:1024 lds
    buffer_load_dwordx4 v242, s[48:51], s60 offen offset:2048 lds
    buffer_load_dwordx4 v243, s[48:51], s60 offen offset:3072 lds
    s_add_u32 s81, s81, 16384
    s_waitcnt vmcnt(16)
    s_barrier
    s_and_b32 s90, s66, 15
    s_lshr_b64 s[66:67], s[66:67], 4
    s_lshl_b32 s90, s90, 19
    s_add_u32 s90, s90, s80
    s_add_u32 m0, s81, 0
    s_add_u32 s60, s90, 0
    buffer_load_dwordx4 v240, s[48:51], s60 offen offset:0 lds
    buffer_load_dwordx4 v241, s[48:51], s60 offen offset:1024 lds
    buffer_load_dwordx4 v242, s[48:51], s60 offen offset:2048 lds
    buffer_load_dwordx4 v243, s[48:51], s60 offen offset:3072 lds
    s_waitcnt vmcnt(12)
    s_barrier
    s_add_u32 m0, s81, 4096
    s_add_u32 s60, s90, 131072
    buffer_load_dwordx4 v240, s[48:51], s60 offen offset:0 lds
    buffer_load_dwordx4 v241, s[48:51], s60 offen offset:1024 lds
    buffer_load_dwordx4 v242, s[48:51], s60 offen offset:2048 lds
    buffer_load_dwordx4 v243, s[48:51], s60 offen offset:3072 lds
    s_add_u32 s81, s81, 16384
    s_add_u32 m0, s83, 65536
    s_add_u32 s60, s82, 0
    buffer_load_dwordx4 v12, s[32:35], s60 offen offset:0 sc1 lds
    buffer_load_dwordx4 v12, s[32:35], s60 offen offset:1024 sc1 lds
    buffer_load_dwordx4 v12, s[32:35], s60 offen offset:2048 sc1 lds
    buffer_load_dwordx4 v12, s[32:35], s60 offen offset:3072 sc1 lds
    s_add_u32 m0, s83, 69632
    s_add_u32 s60, s82, 20480
    buffer_load_dwordx4 v12, s[32:35], s60 offen offset:0 sc1 lds
    buffer_load_dwordx4 v12, s[32:35], s60 offen offset:1024 sc1 lds
    buffer_load_dwordx4 v12, s[32:35], s60 offen offset:2048 sc1 lds
    buffer_load_dwordx4 v12, s[32:35], s60 offen offset:3072 sc1 lds
    s_waitcnt vmcnt(16)
    s_barrier
    s_add_u32 m0, s83, 81920
    s_add_u32 s60, s82, 4096
    buffer_load_dwordx4 v12, s[32:35], s60 offen offset:0 sc1 lds
    buffer_load_dwordx4 v12, s[32:35], s60 offen offset:1024 sc1 lds
    buffer_load_dwordx4 v12, s[32:35], s60 offen offset:2048 sc1 lds
    buffer_load_dwordx4 v12, s[32:35], s60 offen offset:3072 sc1 lds
    s_add_u32 m0, s83, 86016
    s_add_u32 s60, s82, 24576
    buffer_load_dwordx4 v12, s[32:35], s60 offen offset:0 sc1 lds
    buffer_load_dwordx4 v12, s[32:35], s60 offen offset:1024 sc1 lds
    buffer_load_dwordx4 v12, s[32:35], s60 offen offset:2048 sc1 lds
    buffer_load_dwordx4 v12, s[32:35], s60 offen offset:3072 sc1 lds
    s_waitcnt vmcnt(16)
    s_barrier
    s_add_u32 m0, s83, 98304
    s_add_u32 s60, s82, 8192
    buffer_load_dwordx4 v12, s[32:35], s60 offen offset:0 sc1 lds
    buffer_load_dwordx4 v12, s[32:35], s60 offen offset:1024 sc1 lds
    buffer_load_dwordx4 v12, s[32:35], s60 offen offset:2048 sc1 lds
    buffer_load_dwordx4 v12, s[32:35], s60 offen offset:3072 sc1 lds
    s_add_u32 m0, s83, 102400
    s_add_u32 s60, s82, 28672
    buffer_load_dwordx4 v12, s[32:35], s60 offen offset:0 sc1 lds
    buffer_load_dwordx4 v12, s[32:35], s60 offen offset:1024 sc1 lds
    buffer_load_dwordx4 v12, s[32:35], s60 offen offset:2048 sc1 lds
    buffer_load_dwordx4 v12, s[32:35], s60 offen offset:3072 sc1 lds
    s_waitcnt vmcnt(16)
    s_barrier
    s_add_u32 m0, s83, 114688
    s_add_u32 s60, s82, 12288
    buffer_load_dwordx4 v12, s[32:35], s60 offen offset:0 sc1 lds
    buffer_load_dwordx4 v12, s[32:35], s60 offen offset:1024 sc1 lds
    buffer_load_dwordx4 v12, s[32:35], s60 offen offset:2048 sc1 lds
    buffer_load_dwordx4 v12, s[32:35], s60 offen offset:3072 sc1 lds
    s_add_u32 m0, s83, 118784
    s_add_u32 s60, s82, 32768
    buffer_load_dwordx4 v12, s[32:35], s60 offen offset:0 sc1 lds
    buffer_load_dwordx4 v12, s[32:35], s60 offen offset:1024 sc1 lds
    buffer_load_dwordx4 v12, s[32:35], s60 offen offset:2048 sc1 lds
    buffer_load_dwordx4 v12, s[32:35], s60 offen offset:3072 sc1 lds
    s_waitcnt vmcnt(16)
    s_barrier
    s_add_u32 m0, s83, 0
    s_add_u32 s60, s82, 16384
    buffer_load_dwordx4 v12, s[32:35], s60 offen offset:0 sc1 lds
    buffer_load_dwordx4 v12, s[32:35], s60 offen offset:1024 sc1 lds
    buffer_load_dwordx4 v12, s[32:35], s60 offen offset:2048 sc1 lds
    buffer_load_dwordx4 v12, s[32:35], s60 offen offset:3072 sc1 lds
    s_add_u32 m0, s83, 4096
    s_add_u32 s60, s82, 36864
    buffer_load_dwordx4 v12, s[32:35], s60 offen offset:0 sc1 lds
    buffer_load_dwordx4 v12, s[32:35], s60 offen offset:1024 sc1 lds
    buffer_load_dwordx4 v12, s[32:35], s60 offen offset:2048 sc1 lds
    buffer_load_dwordx4 v12, s[32:35], s60 offen offset:3072 sc1 lds
    s_waitcnt vmcnt(16)
    s_barrier
    s_waitcnt vmcnt(8)
    s_barrier
    s_waitcnt vmcnt(0)
    s_barrier
    s_branch L_end
L_F_poller:
    s_cmp_eq_u32 s95, 1
    s_cbranch_scc1 L_F_pnowot
    s_mul_i32 s60, s77, 128
    s_add_u32 s60, s60, 69632
    v_mov_b32 v2, s60
    s_mov_b32 s78, 0
Lpoll_24:
    buffer_load_dword v4, v2, s[32:35], 0 offen sc1
    s_waitcnt vmcnt(0)
    v_cmp_ne_u32 vcc, s28, v4
    s_nop 1
    s_cmp_eq_u64 vcc, 0
    s_cbranch_scc1 Lpdone_25
    s_add_u32 s78, s78, 1
    s_cmp_lt_u32 s78, 131072
    s_cbranch_scc0 Lpdone_25
    s_sleep 1
    s_branch Lpoll_24
Lpdone_25:
    s_barrier
L_F_pnowot:
    s_mul_i32 s60, s77, 5
    s_lshr_b32 s61, s60, 3
    s_add_u32 s60, s60, 4
    s_lshr_b32 s60, s60, 3
    s_mul_i32 s60, s60, 24
    s_mul_i32 s61, s61, 24
    v_and_b32 v2, 31, v1
    v_min_u32 v2, 23, v2
    v_add_u32 v3, s60, v2
    v_add_u32 v2, s61, v2
    v_cmp_gt_u32 vcc, 32, v1
    s_mul_i32 s60, s77, 128
    s_add_u32 s60, s60, 69632
    v_cndmask_b32 v2, v2, v3, vcc
    v_mul_u32_u24 v2, 128, v2
    v_add_u32 v2, 36864, v2
    v_mov_b32 v3, s60
    v_cmp_eq_u32 vcc, 63, v1
    s_nop 1
    v_cndmask_b32 v2, v2, v3, vcc
    s_mov_b32 s78, 0
Lpoll_26:
    buffer_load_dword v4, v2, s[32:35], 0 offen sc1
    s_waitcnt vmcnt(0)
    v_cmp_ne_u32 vcc, s28, v4
    s_nop 1
    s_cmp_eq_u64 vcc, 0
    s_cbranch_scc1 Lpdone_27
    s_add_u32 s78, s78, 1
    s_cmp_lt_u32 s78, 131072
    s_cbranch_scc0 Lpdone_27
    s_sleep 1
    s_branch Lpoll_26
Lpdone_27:
    s_barrier
    v_and_b32 v2, 7, v1
    s_lshr_b32 s60, s76, 1
    s_lshl_b32 s60, s60, 3
    v_add_u32 v2, s60, v2
    v_mul_u32_u24 v2, 128, v2
    v_add_u32 v2, 53248, v2
    s_barrier
    s_barrier
    s_cmp_eq_u32 s95, 1
    s_cbranch_scc0 L_F_nogo
    s_lshl_b32 s60, s70, 3
    s_add_u32 s60, s60, s71
    s_mul_i32 s60, s60, 128
    s_add_u32 s60, s60, 53248
    v_mov_b32 v6, s28
    v_mov_b32 v7, 0
    s_mov_b64 exec, 1
    buffer_store_dword v6, v7, s[32:35], s60 offen sc1
    s_mov_b64 exec, -1
L_F_nogo:
    s_barrier
    s_barrier
    s_barrier
    s_barrier
    s_barrier
    buffer_load_dword v8, v2, s[32:35], 0 offen sc1
    s_barrier
    s_barrier
    s_waitcnt vmcnt(0)
    v_cmp_ne_u32 vcc, s28, v8
    s_nop 1
    s_cmp_eq_u64 vcc, 0
    s_cbranch_scc1 L_F_gook
    s_mov_b32 s78, 0
Lpoll_28:
    buffer_load_dword v4, v2, s[32:35], 0 offen sc1
    s_waitcnt vmcnt(0)
    v_cmp_ne_u32 vcc, s28, v4
    s_nop 1
    s_cmp_eq_u64 vcc, 0
    s_cbranch_scc1 Lpdone_29
    s_add_u32 s78, s78, 1
    s_cmp_lt_u32 s78, 131072
    s_cbranch_scc0 Lpdone_29
    s_sleep 1
    s_branch Lpoll_28
Lpdone_29:
L_F_gook:
    s_barrier
    s_barrier
    s_barrier
    s_barrier
    s_barrier
    s_barrier
    s_barrier
    s_barrier
L_end:
L_exit:
    s_endpgm
.section .rodata,"a"
.p2align 6
.amdhsa_kernel gated_mix__linear_attn_block__mixer_token_mlp__prompt_kernel
  .amdhsa_next_free_vgpr 256
  .amdhsa_next_free_sgpr 102
  .amdhsa_accum_offset 256
  .amdhsa_group_segment_fixed_size 0
  .amdhsa_kernarg_size 96
  .amdhsa_user_sgpr_count 2
  .amdhsa_user_sgpr_kernarg_segment_ptr 1
  .amdhsa_system_sgpr_workgroup_id_x 1
  .amdhsa_float_denorm_mode_32 3
.end_amdhsa_kernel
```
